```python
import torch

def _softmax(x, axis=-1):
    return torch.softmax(x, dim=axis)
def _gelu(x):
    return torch.nn.functional.gelu(x, approximate="tanh")
def _silu(x):
    return torch.nn.functional.silu(x)
def _sigmoid(x):
    return torch.sigmoid(x)
def _layernorm(x, axis=-1, eps=1e-5):
    m = x.mean(dim=axis, keepdim=True)
    v = x.var(dim=axis, keepdim=True, unbiased=False)
    return (x - m) / torch.sqrt(v + eps)
def _scatter_add(tgt, idx, src, axis=0):
    return tgt.clone().index_add_(axis, idx, src)
def _segment_sum(src, seg, n):
    out = torch.zeros((n,) + src.shape[1:], dtype=src.dtype)
    return out.index_add_(0, seg, src)
def _pad(x, pw):
    flat = tuple(v for pair in reversed(pw) for v in pair)
    return torch.nn.functional.pad(x, flat)

kernel_name = 'gated_mix__softmax_full_mha__dense_activation_mish__prompt'

def setup_inputs():

    _w = (lambda a: (lambda t: t.to(torch.bfloat16) if t.is_floating_point() else t)(torch.as_tensor(a)))
    def _A_setup():
        B, S, D = 1, 2048, 448
        return {
            "x": _w((lambda *s: torch.randn(*s, dtype=torch.bfloat16) * 0.05)(B, S, D)),
            "wqkv": _w((lambda *s: torch.randn(*s, dtype=torch.bfloat16) * 0.8)(D, 3 * D)),
            "wo": _w((lambda *s: torch.randn(*s, dtype=torch.bfloat16) * 0.05)(D, D)),
        }
    _A_in = _A_setup()

    def _B_setup():
        B, S, D, F = 1, 2048, 448, 1792
        return {
            "x": _w((lambda *s: torch.randn(*s, dtype=torch.bfloat16) * 0.05)(B, S, D)),
            "w1": _w((lambda *s: torch.randn(*s, dtype=torch.bfloat16) * 12.8)(D, F) * (D ** -0.5)),
            "b1": _w((lambda *s: torch.randn(*s, dtype=torch.bfloat16) * 0.1)(F)),
            "w2": _w((lambda *s: torch.randn(*s, dtype=torch.bfloat16) * 0.1)(F, D) * (F ** -0.5)),
        }
    _B_in = _B_setup()

    return {
        "A_x": _A_in["x"],
        "A_wqkv": _A_in["wqkv"],
        "A_wo": _A_in["wo"],
        "B_x": _B_in["x"],
        "B_w1": _B_in["w1"],
        "B_b1": _B_in["b1"],
        "B_w2": _B_in["w2"],
        "gate_w": _w((lambda *s: torch.randn(*s, dtype=torch.bfloat16) * 0.05)(448) * 16.0),
    }

def reference(A_x, A_wqkv, A_wo, B_x, B_w1, B_b1, B_w2, gate_w):
    def _A_ref(x, wqkv, wo):
        B, S, D = x.shape
        H = 16; Dh = D // H
        qkv = (lambda x, *d: x.permute(*d))((x @ wqkv).reshape(B, S, 3, H, Dh), 2, 0, 3, 1, 4)
        q, k, v = qkv[0], qkv[1], qkv[2]
        scale = Dh ** -0.5
        scores = torch.einsum("bhqd,bhkd->bhqk", q, k) * scale
        p = _softmax(scores, axis=-1)
        o = torch.einsum("bhqk,bhkd->bhqd", p, v)
        return (lambda x, *d: x.permute(*d))(o, 0, 2, 1, 3).reshape(B, S, D) @ wo

    def _B_ref(x, w1, b1, w2):
        h = torch.einsum("bsd,df->bsf", x, w1) + b1
        sp = torch.log1p(torch.exp(-torch.abs(h))) + torch.where(h > 0, h, torch.zeros_like(h))
        act = h * torch.tanh(sp)
        return torch.einsum("bsf,fd->bsd", act, w2)

    x = A_x
    g = _sigmoid((x * gate_w).sum(-1, keepdims=True))
    a = _A_ref(x, A_wqkv, A_wo)
    b = _B_ref(x, B_w1, B_b1, B_w2)
    return g * a + (1 - g) * b
```

```asm
; @launch grid=(256,1,1) block=(256,1,1) lds=163840
.amdgcn_target "amdgcn-amd-amdhsa--gfx950"
.text
.globl gated_mix__softmax_full_mha__dense_activation_mish__prompt_kernel
.p2align 8
.type gated_mix__softmax_full_mha__dense_activation_mish__prompt_kernel,@function
.set CODE_LAST, 291
gated_mix__softmax_full_mha__dense_activation_mish__prompt_kernel:
    s_cmp_ge_u32 s2, 0x100
    s_cbranch_scc1 L_end
    s_load_dwordx2 s[8:9], s[0:1], 0
    s_load_dwordx2 s[12:13], s[0:1], 8
    s_load_dwordx2 s[16:17], s[0:1], 32
    s_getpc_b64 s[54:55]
L_pc:
    s_lshr_b32 s52, s2, 3
    v_lshrrev_b32 v2, 4, v0
    v_lshl_add_u32 v2, s52, 4, v2
    v_min_u32 v2, CODE_LAST, v2
    v_lshlrev_b32 v2, 7, v2
    global_load_dword v35, v2, s[54:55]
    v_lshrrev_b32 v41, 6, v0
    v_and_b32 v1, 63, v0
    s_and_b32 s52, s52, 7
    s_and_b32 s53, s2, 1
    v_readfirstlane_b32 s5, v41
    s_lshl3_add_u32 s3, s53, s52
    s_bfe_u32 s53, s2, 0x20001
    s_lshr_b32 s54, s2, 6
    s_lshl2_add_u32 s4, s53, s54
    s_cmp_ge_u32 s2, 0xe0
    s_cselect_b32 s7, 4, 0
    s_xor_b32 s7, s7, s4
    s_lshr_b32 s53, s7, 3
    s_sub_u32 s6, s7, s53
    s_and_b32 s53, s7, 7
    s_cmp_eq_u32 s53, 7
    s_cselect_b32 s46, 0x40000000, 0
    s_mul_i32 s52, s52, 3
    s_lshl1_add_u32 s52, s54, s52
    s_mul_i32 s53, s52, 37
    s_lshr_b32 s53, s53, 8
    s_mul_i32 s53, s53, 7
    s_sub_u32 s60, s52, s53
    s_mov_b32 s10, 0x1c0000
    s_mov_b32 s11, 0x20000
    s_mov_b32 s14, 0x126000
    s_mov_b32 s15, 0x20000
    s_mov_b32 s18, 0x188000
    s_mov_b32 s19, 0x20000
    v_lshrrev_b32 v41, 3, v1
    v_and_b32 v42, 7, v1
    v_lshrrev_b32 v43, 4, v1
    v_xor_b32 v44, v42, v43
    v_mul_u32_u24 v5, 896, v41
    v_lshl_add_u32 v5, v44, 4, v5
    v_xor_b32 v6, 64, v5
    v_add_u32 v6, 6144, v6
    v_add_u32 v7, 12288, v5
    v_add_u32 v8, 12288, v6
    s_lshl_b32 s51, s5, 12
    s_lshl2_add_u32 s69, s3, s5
    s_mul_i32 s48, s69, 28672
    s_mov_b32 s61, s60
    s_add_u32 m0, s51, 0
    s_lshl_b32 s52, s60, 7
    s_add_u32 s52, s52, s48
    s_waitcnt lgkmcnt(0)
    buffer_load_dwordx4 v5, s[8:11], s52 offen offset:0  lds
    buffer_load_dwordx4 v6, s[8:11], s52 offen offset:1024  lds
    s_mul_i32 s53, s60, 172032
    v_and_b32 v43, 1, v43
    v_lshlrev_b32 v43, 2, v43
    v_xor_b32 v44, v42, v43
    v_lshlrev_b32 v44, 4, v44
    v_mul_u32_u24 v9, 2688, v41
    v_add_u32 v9, v9, v44
    v_add_u32 v10, 20480, v9
    s_mul_i32 s55, s5, 43008
    s_lshl_b32 s49, s6, 7
    s_add_u32 s49, s49, s55
    s_add_u32 s49, s49, 896
    s_add_u32 s49, s49, s46
    buffer_load_dwordx4 v7, s[8:11], s52 offen offset:2048  lds
    s_mul_i32 s54, s60, 229376
    buffer_load_dwordx4 v8, s[8:11], s52 offen offset:3072  lds
    s_add_u32 m0, s51, 49152
    s_add_u32 s53, s53, s49
    v_mul_u32_u24 v11, 3584, v41
    v_add_u32 v11, v11, v44
    v_add_u32 v12, 27648, v11
    s_mul_i32 s50, s5, 57344
    s_lshl_b32 s44, s6, 8
    s_add_u32 s50, s50, s44
    s_add_u32 s50, s50, s46
    buffer_load_dwordx4 v9, s[12:15], s53 offen offset:0  lds
    s_add_u32 s54, s54, s50
    buffer_load_dwordx4 v10, s[12:15], s53 offen offset:1024  lds
    s_add_u32 m0, s51, 51200
    s_add_u32 s60, s60, 1
    s_cmp_eq_u32 s60, 7
    s_cselect_b32 s60, 0, s60
    buffer_load_dwordx4 v11, s[16:19], s54 offen offset:0  lds
    buffer_load_dwordx4 v12, s[16:19], s54 offen offset:1024  lds
    s_cmp_ge_u32 s50, 0x40000000
    s_cbranch_scc1 L_touch
L_touched:
    s_load_dwordx2 s[24:25], s[0:1], 40
    s_load_dwordx2 s[36:37], s[0:1], 56
    s_load_dwordx2 s[20:21], s[0:1], 80
    s_load_dwordx2 s[28:29], s[0:1], 48
    s_load_dwordx2 s[32:33], s[0:1], 16
    s_load_dwordx2 s[40:41], s[0:1], 64
    v_mul_u32_u24 v176, 896, v41
    v_add_u32 v176, v176, v44
    s_mov_b32 s26, 0xe00
    s_mov_b32 s27, 0x20000
    s_mov_b32 s38, 0x380
    s_mov_b32 s39, 0x20000
    s_mov_b32 s22, 0x2000000
    s_mov_b32 s23, 0x20000
    v_lshrrev_b32 v41, 5, v1
    v_lshlrev_b32 v191, 4, v41
    s_and_b32 s63, s5, 1
    s_and_b32 s62, s4, 1
    s_lshl_b32 s45, s63, 6
    s_add_u32 s44, s44, s45
    s_waitcnt lgkmcnt(0)
    buffer_load_dwordx4 v[232:235], v191, s[24:27], s44 offen offset:0
    buffer_load_dwordx4 v[236:239], v191, s[24:27], s44 offen offset:32
    buffer_load_dwordx4 v[200:203], v191, s[24:27], s44 offen offset:128
    buffer_load_dwordx4 v[204:207], v191, s[24:27], s44 offen offset:160
    v_lshrrev_b32 v25, 4, v1
    v_add_u32 v26, 4, v25
    v_min_u32 v26, 6, v26
    v_and_b32 v29, 15, v1
    s_lshl_b32 s45, s5, 5
    v_lshl_add_u32 v43, v29, 1, s45
    v_add_u32 v27, s61, v25
    v_add_u32 v44, -7, v27
    v_min_u32 v27, v27, v44
    v_lshl_add_u32 v27, v27, 7, v43
    v_add_u32 v28, s61, v26
    v_add_u32 v44, -7, v28
    v_min_u32 v28, v28, v44
    v_lshl_add_u32 v28, v28, 7, v43
    v_and_b32 v42, 31, v1
    v_bfe_u32 v43, v1, 1, 3
    v_xor_b32 v43, v43, v41
    v_lshlrev_b32 v43, 4, v43
    v_lshl_add_u32 v43, v42, 7, v43
    v_add_u32 v14, s51, v43
    v_xor_b32 v15, 32, v14
    v_xor_b32 v16, 64, v14
    v_xor_b32 v17, 96, v14
    v_xor_b32 v18, 0x1000, v14
    v_xor_b32 v19, 0x1000, v15
    v_xor_b32 v20, 0x1000, v16
    v_xor_b32 v21, 0x1000, v17
    v_bfe_u32 v44, v1, 2, 2
    v_and_b32 v45, 1, v1
    v_lshlrev_b32 v45, 4, v45
    v_and_b32 v46, 2, v1
    v_lshl_add_u32 v45, v46, 2, v45
    v_and_b32 v46, 16, v1
    v_lshl_add_u32 v45, v46, 1, v45
    v_lshl_add_u32 v46, v41, 3, v44
    v_lshl_add_u32 v23, v46, 6, v45
    v_lshl_add_u32 v180, v46, 7, v45
    v_lshrrev_b32 v44, 1, v44
    v_xor_b32 v44, s63, v44
    v_lshl_add_u32 v180, v44, 6, v180
    v_add_u32 v22, 0xc000, v180
    v_lshlrev_b32 v2, 4, v1
    v_mov_b32 v46, 0x40000000
    s_lshl4_add_u32 s47, s69, s4
    s_lshl_b32 s47, s47, 11
    s_add_u32 s81, s47, 0x430000
    s_mov_b32 s89, s61
    s_mul_i32 s88, s4, 56
    s_add_u32 s88, s88, s55
    s_lshl_b32 s44, s62, 3
    s_sub_u32 s88, s88, s44
    v_lshrrev_b32 v43, 2, v1
    v_mul_u32_u24 v13, 2688, v43
    v_and_b32 v43, 3, v1
    v_lshl_add_u32 v13, v43, 4, v13
    s_mov_b32 s72, 0x3fb8aa3b
    s_cmp_eq_u32 s62, 0
    s_cselect_b32 s44, 56, 0
    s_lshr_b32 s45, s51, 2
    s_add_u32 s44, s44, s45
    s_add_u32 s44, s44, 0x20000
    v_lshl_add_u32 v44, v29, 6, s44
    v_lshl_add_u32 v25, v25, 12, v44
    v_lshl_add_u32 v26, v26, 12, v44
    v_add_u32 v23, 0x20000, v23
    v_xor_b32 v43, 1, v41
    v_and_b32 v43, s62, v43
    v_add_u32 v29, -1, v43
    s_xor_b32 s44, s62, 1
    v_and_b32 v43, s44, v41
    v_add_u32 v30, -1, v43
    v_add_u32 v37, -1, v41
    v_lshlrev_b32 v40, 2, v42
    v_cmp_gt_u32 vcc, 29, v42
    s_lshl4_add_u32 s44, s3, s7
    s_lshl_b32 s44, s44, 7
    v_cndmask_b32 v36, v46, v2, vcc
    v_mov_b32 v43, s44
    v_cmp_eq_u32 vcc, 0, v0
    v_mul_u32_u24 v44, 896, v42
    v_add_u32 v191, v191, v44
    v_cndmask_b32 v4, v46, v43, vcc
    s_mov_b32 s30, 0x188000
    s_mov_b32 s31, 0x20000
    s_mov_b32 s34, 0x62000
    s_mov_b32 s35, 0x20000
    s_mov_b32 s42, 0x1c0000
    s_mov_b32 s43, 0x20000
    s_mul_i32 s44, s4, 28
    s_lshl_b32 s45, s62, 2
    s_sub_u32 s45, s44, s45
    s_lshl_b32 s74, s45, 6
    s_mul_i32 s46, s5, 458752
    s_add_u32 s74, s74, s46
    s_add_u32 s74, s74, 0x10000
    s_lshl2_add_u32 s75, s4, s5
    s_lshl_b32 s75, s75, 15
    s_add_u32 s75, s75, 0x220000
    s_add_u32 s76, s75, 0x8000
    s_and_b32 s46, s3, 0
    s_mul_i32 s66, s46, 57344
    s_add_u32 s66, s66, s74
    s_lshl_b32 s67, s46, 12
    s_add_u32 s67, s67, s75
    s_lshr_b32 s46, s45, 6
    s_lshl_b32 s64, 1, s46
    s_add_u32 s46, s45, 31
    s_lshr_b32 s46, s46, 6
    s_bitset1_b32 s64, s46
    s_lshr_b32 s46, s44, 6
    s_add_u32 s46, s46, 8
    s_bitset1_b32 s64, s46
    s_add_u32 s46, s44, 27
    s_lshr_b32 s46, s46, 6
    s_add_u32 s46, s46, 8
    s_bitset1_b32 s64, s46
    s_or_b32 s46, s4, 7
    s_bitset1_b32 s64, s46
    s_mul_i32 s64, s64, 0x10001
    s_mov_b32 s65, s64
    v_lshlrev_b32 v43, 7, v1
    v_cmp_gt_u32 vcc, 16, v1
    v_cndmask_b32 v34, v46, v43, s[64:65]
    s_lshl_b32 s44, s5, 11
    v_cndmask_b32 v38, v46, v43, vcc
    s_add_u32 s44, s44, 0x1e000
    v_add_u32 v39, s44, v2
    v_add_u32 v177, 6144, v176
    v_add_u32 v178, 12288, v176
    v_add_u32 v179, 18432, v176
    s_lshl_b32 s71, s5, 14
    s_lshl_b32 s73, s5, 13
    s_add_u32 s73, s73, 0x20000
    v_add_u32 v182, s73, v180
    v_add_u32 v180, s71, v180
    v_add_u32 v184, 0x10000, v180
    v_xor_b32 v181, 64, v180
    v_xor_b32 v183, 64, v182
    v_xor_b32 v185, 64, v184
    v_add_u32 v187, s71, v2
    s_xor_b32 s44, s73, 24576
    v_xor_b32 v188, 16384, v187
    v_xor_b32 v189, 32768, v187
    v_add_u32 v190, s44, v2
    s_lshr_b32 s44, s2, 3
    s_mul_i32 s45, s44, 37
    s_lshr_b32 s45, s45, 8
    s_mul_i32 s46, s45, 7
    s_sub_u32 s46, s44, s46
    s_cmp_eq_u32 s45, 4
    s_cselect_b32 s82, 0x40000000, 0
    s_min_u32 s45, s45, 3
    s_bfe_u32 s44, s2, 0x20001
    s_andn2_b32 s47, 1, s2
    s_lshl2_add_u32 s44, s47, s44
    s_lshl2_add_u32 s44, s44, s45
    s_lshr_b32 s47, s5, 1
    s_lshl1_add_u32 s85, s44, s47
    s_mul_i32 s77, s44, 270336
    s_mul_i32 s45, s45, 0
    s_and_b32 s44, s46, 0
    s_mul_i32 s44, s44, 0
    s_add_u32 s45, s45, s44
    s_and_b32 s44, s2, 7
    s_mul_i32 s44, s44, 1
    s_add_u32 s45, s45, s44
    s_mul_i32 s44, s45, 37
    s_lshr_b32 s44, s44, 8
    s_mul_i32 s44, s44, 7
    s_sub_u32 s45, s45, s44
    s_lshl_b32 s46, s46, 7
    s_mul_i32 s44, s5, 28672
    s_add_u32 s77, s77, s44
    s_add_u32 s77, s77, 0x634000
    s_add_u32 s77, s77, s82
    s_add_u32 s78, s77, 28672
    s_lshl_b32 s68, s45, 12
    s_add_u32 s68, s68, s77
    s_mul_i32 s47, s47, 135168
    v_add_u32 v0, s47, v2
    s_sub_u32 s47, 135168, s47
    v_add_u32 v186, s47, v2
    s_mul_i32 s79, s5, 401408
    s_add_u32 s79, s79, s46
    s_add_u32 s79, s79, s82
    s_add_u32 s84, s79, 401408
    s_mul_i32 s70, s45, 57344
    s_add_u32 s70, s70, s79
    s_mul_i32 s87, s5, 25088
    s_add_u32 s87, s87, s46
    s_add_u32 s87, s87, s82
    s_mul_i32 s86, s85, 28672
    s_add_u32 s86, s86, s46
    s_lshl_b32 s44, s63, 6
    s_add_u32 s86, s86, s44
    buffer_load_dword v3, off, s[20:23], 0 sc1
    buffer_load_ushort v27, v27, s[36:39], 0 offen
    buffer_load_ushort v28, v28, s[36:39], 0 offen
    s_cmp_ge_u32 s50, 0x40000000
    s_cbranch_scc1 L_idle
    s_add_u32 m0, s51, 16384
    s_lshl_b32 s52, s60, 7
    s_add_u32 s52, s52, s48
    buffer_load_dwordx4 v5, s[8:11], s52 offen offset:0  lds
    buffer_load_dwordx4 v6, s[8:11], s52 offen offset:1024  lds
    s_mul_i32 s53, s60, 172032
    buffer_load_dwordx4 v7, s[8:11], s52 offen offset:2048  lds
    s_mul_i32 s54, s60, 229376
    buffer_load_dwordx4 v8, s[8:11], s52 offen offset:3072  lds
    s_add_u32 m0, s51, 65536
    s_add_u32 s53, s53, s49
    buffer_load_dwordx4 v9, s[12:15], s53 offen offset:0  lds
    s_add_u32 s54, s54, s50
    buffer_load_dwordx4 v10, s[12:15], s53 offen offset:1024  lds
    s_add_u32 m0, s51, 67584
    s_add_u32 s60, s60, 1
    s_cmp_eq_u32 s60, 7
    s_cselect_b32 s60, 0, s60
    buffer_load_dwordx4 v11, s[16:19], s54 offen offset:0  lds
    buffer_load_dwordx4 v12, s[16:19], s54 offen offset:1024  lds
    s_waitcnt vmcnt(13)
    v_lshlrev_b32 v224, 16, v232
    v_and_b32 v225, 0xffff0000, v232
    v_lshlrev_b32 v226, 16, v233
    v_and_b32 v227, 0xffff0000, v233
    v_lshlrev_b32 v228, 16, v234
    v_and_b32 v229, 0xffff0000, v234
    v_lshlrev_b32 v230, 16, v235
    v_and_b32 v231, 0xffff0000, v235
    v_lshlrev_b32 v232, 16, v236
    v_and_b32 v233, 0xffff0000, v236
    v_lshlrev_b32 v234, 16, v237
    v_and_b32 v235, 0xffff0000, v237
    v_lshlrev_b32 v236, 16, v238
    v_and_b32 v237, 0xffff0000, v238
    v_lshlrev_b32 v238, 16, v239
    v_and_b32 v239, 0xffff0000, v239
    s_barrier
    ds_read_b64_tr_b16 v[48:49], v22 offset:0
    ds_read_b64_tr_b16 v[50:51], v22 offset:512
    ds_read_b128 a[0:3], v14 offset:0
    ds_read_b128 a[4:7], v18 offset:0
    ds_read_b64_tr_b16 v[52:53], v22 offset:2048
    ds_read_b64_tr_b16 v[54:55], v22 offset:2560
    ds_read_b64_tr_b16 v[56:57], v22 offset:4096
    ds_read_b64_tr_b16 v[58:59], v22 offset:4608
    ds_read_b128 a[8:11], v15 offset:0
    ds_read_b128 a[12:15], v19 offset:0
    ds_read_b64_tr_b16 v[60:61], v22 offset:6144
    ds_read_b64_tr_b16 v[62:63], v22 offset:6656
    s_cmp_ge_u32 s6, 7
    s_cbranch_scc1 L_p1v
    s_waitcnt lgkmcnt(9)
    v_mfma_f32_32x32x16_bf16 v[80:95], v[48:51], a[0:3], 0
    ds_read_b64_tr_b16 v[64:65], v22 offset:8192
    ds_read_b64_tr_b16 v[66:67], v22 offset:8704
    ds_read_b128 a[16:19], v16 offset:0
    s_add_u32 m0, s51, 32768
    s_lshl_b32 s52, s60, 7
    s_add_u32 s52, s52, s48
    buffer_load_dwordx4 v5, s[8:11], s52 offen offset:0  lds
    s_waitcnt lgkmcnt(11)
    v_mfma_f32_32x32x16_bf16 v[96:111], v[48:51], a[4:7], 0
    ds_read_b128 a[20:23], v20 offset:0
    ds_read_b64_tr_b16 v[68:69], v22 offset:10240
    ds_read_b64_tr_b16 v[70:71], v22 offset:10752
    buffer_load_dwordx4 v6, s[8:11], s52 offen offset:1024  lds
    s_mul_i32 s53, s60, 172032
    s_waitcnt lgkmcnt(12)
    v_mfma_f32_32x32x16_bf16 v[112:127], v[52:55], a[0:3], v[224:239]
    buffer_load_dwordx4 v7, s[8:11], s52 offen offset:2048  lds
    s_mul_i32 s54, s60, 229376
    s_xor_b32 s45, s69, 1
    s_lshl2_add_u32 s46, s6, s63
    v_mfma_f32_32x32x16_bf16 v[128:143], v[52:55], a[4:7], v[224:239]
    s_waitcnt lgkmcnt(6)
    buffer_load_dwordx4 v8, s[8:11], s52 offen offset:3072  lds
    s_add_u32 m0, s51, 81920
    s_add_u32 s53, s53, s49
    s_lshl_b32 s46, s46, 11
    s_add_u32 s46, s46, 0x634000
    v_mfma_f32_32x32x16_bf16 v[80:95], v[56:59], a[8:11], v[80:95]
    ds_read_b64_tr_b16 v[72:73], v22 offset:12288
    ds_read_b64_tr_b16 v[74:75], v22 offset:12800
    ds_read_b128 a[24:27], v17 offset:0
    buffer_load_dwordx4 v9, s[12:15], s53 offen offset:0  lds
    s_add_u32 s54, s54, s50
    v_mfma_f32_32x32x16_bf16 v[96:111], v[56:59], a[12:15], v[96:111]
    ds_read_b128 a[28:31], v21 offset:0
    ds_read_b64_tr_b16 v[76:77], v22 offset:14336
    ds_read_b64_tr_b16 v[78:79], v22 offset:14848
    buffer_load_dwordx4 v10, s[12:15], s53 offen offset:1024  lds
    s_add_u32 m0, s51, 83968
    s_add_u32 s60, s60, 1
    s_cmp_eq_u32 s60, 7
    s_cselect_b32 s60, 0, s60
    v_mfma_f32_32x32x16_bf16 v[112:127], v[60:63], a[8:11], v[112:127]
    buffer_load_dwordx4 v11, s[16:19], s54 offen offset:0  lds
    s_mul_i32 s58, s69, 135168
    s_add_u32 s58, s58, s46
    v_mfma_f32_32x32x16_bf16 v[128:143], v[60:63], a[12:15], v[128:143]
    s_waitcnt lgkmcnt(6)
    buffer_load_dwordx4 v12, s[16:19], s54 offen offset:1024  lds
    s_mul_i32 s59, s45, 135168
    s_add_u32 s59, s59, s46
    v_mfma_f32_32x32x16_bf16 v[80:95], v[64:67], a[16:19], v[80:95]
    s_waitcnt vmcnt(8) lgkmcnt(0)
    s_barrier
    ds_read_b64_tr_b16 v[48:49], v22 offset:16384
    ds_read_b64_tr_b16 v[50:51], v22 offset:16896
    ds_read_b128 a[32:35], v14 offset:16384
    v_mfma_f32_32x32x16_bf16 v[96:111], v[64:67], a[20:23], v[96:111]
    ds_read_b128 a[36:39], v18 offset:16384
    ds_read_b64_tr_b16 v[52:53], v22 offset:18432
    ds_read_b64_tr_b16 v[54:55], v22 offset:18944
    s_add_u32 m0, s51, 0
    s_lshl_b32 s52, s60, 7
    s_add_u32 s52, s52, s48
    buffer_load_dwordx4 v5, s[8:11], s52 offen offset:0  lds
    v_mfma_f32_32x32x16_bf16 v[112:127], v[68:71], a[16:19], v[112:127]
    buffer_load_dwordx4 v6, s[8:11], s52 offen offset:1024  lds
    s_mul_i32 s53, s60, 172032
    s_cmp_eq_u32 s4, 0
    s_cselect_b32 s46, 0, 0x40000000
    v_mfma_f32_32x32x16_bf16 v[128:143], v[68:71], a[20:23], v[128:143]
    buffer_load_dwordx4 v7, s[8:11], s52 offen offset:2048  lds
    s_mul_i32 s54, s60, 229376
    s_lshl_b32 s83, s69, 7
    s_add_u32 s83, s83, s46
    v_mfma_f32_32x32x16_bf16 v[80:95], v[72:75], a[24:27], v[80:95]
    ds_read_b64_tr_b16 v[56:57], v22 offset:20480
    ds_read_b64_tr_b16 v[58:59], v22 offset:20992
    ds_read_b128 a[40:43], v15 offset:16384
    s_add_u32 s83, s83, 0x4000
    v_mfma_f32_32x32x16_bf16 v[96:111], v[72:75], a[28:31], v[96:111]
    ds_read_b128 a[44:47], v19 offset:16384
    ds_read_b64_tr_b16 v[60:61], v22 offset:22528
    ds_read_b64_tr_b16 v[62:63], v22 offset:23040
    buffer_load_dwordx4 v8, s[8:11], s52 offen offset:3072  lds
    s_add_u32 m0, s51, 49152
    s_add_u32 s53, s53, s49
    v_mfma_f32_32x32x16_bf16 v[112:127], v[76:79], a[24:27], v[112:127]
    buffer_load_dwordx4 v9, s[12:15], s53 offen offset:0  lds
    s_add_u32 s54, s54, s50
    v_mov_b32 v24, v2
    s_lshl1_add_u32 s46, s6, s63
    v_mfma_f32_32x32x16_bf16 v[128:143], v[76:79], a[28:31], v[128:143]
    s_waitcnt lgkmcnt(6)
    buffer_load_dwordx4 v10, s[12:15], s53 offen offset:1024  lds
    s_add_u32 m0, s51, 51200
    s_add_u32 s60, s60, 1
    s_cmp_eq_u32 s60, 7
    s_cselect_b32 s60, 0, s60
    s_lshl_b32 s46, s46, 11
    s_add_u32 s46, s46, 0x10000
    v_mfma_f32_32x32x16_bf16 v[80:95], v[48:51], a[32:35], v[80:95]
    ds_read_b64_tr_b16 v[64:65], v22 offset:24576
    ds_read_b64_tr_b16 v[66:67], v22 offset:25088
    ds_read_b128 a[48:51], v16 offset:16384
    s_mul_i32 s56, s69, 28672
    v_mfma_f32_32x32x16_bf16 v[96:111], v[48:51], a[36:39], v[96:111]
    ds_read_b128 a[52:55], v20 offset:16384
    ds_read_b64_tr_b16 v[68:69], v22 offset:26624
    ds_read_b64_tr_b16 v[70:71], v22 offset:27136
    buffer_load_dwordx4 v11, s[16:19], s54 offen offset:0  lds
    v_mfma_f32_32x32x16_bf16 v[112:127], v[52:55], a[32:35], v[112:127]
    buffer_load_dwordx4 v12, s[16:19], s54 offen offset:1024  lds
    s_add_u32 s56, s56, s46
    s_mul_i32 s57, s45, 28672
    v_mfma_f32_32x32x16_bf16 v[128:143], v[52:55], a[36:39], v[128:143]
    s_waitcnt lgkmcnt(6)
    s_lshr_b32 s52, s51, 2
    s_add_u32 m0, s52, 131072
    s_mul_i32 s53, s89, 172032
    s_add_u32 s53, s53, s88
    buffer_load_dwordx4 v13, s[12:15], s53 offen  lds
    s_add_u32 s89, s89, 1
    s_cmp_eq_u32 s89, 7
    s_cselect_b32 s89, 0, s89
    s_add_u32 s57, s57, s46
    s_mov_b32 s44, 0x9e3779b1
    v_mul_lo_u32 v3, s44, v3
    v_mfma_f32_32x32x16_bf16 v[80:95], v[56:59], a[40:43], v[80:95]
    ds_read_b64_tr_b16 v[72:73], v22 offset:28672
    ds_read_b64_tr_b16 v[74:75], v22 offset:29184
    ds_read_b128 a[56:59], v17 offset:16384
    v_xor_b32 v3, 0x5bd1e995, v3
    v_mfma_f32_32x32x16_bf16 v[96:111], v[56:59], a[44:47], v[96:111]
    ds_read_b128 a[60:63], v21 offset:16384
    ds_read_b64_tr_b16 v[76:77], v22 offset:30720
    ds_read_b64_tr_b16 v[78:79], v22 offset:31232
    v_lshlrev_b32 v192, 16, v200
    v_mfma_f32_32x32x16_bf16 v[112:127], v[60:63], a[40:43], v[112:127]
    v_and_b32 v193, 0xffff0000, v200
    v_lshlrev_b32 v194, 16, v201
    v_and_b32 v195, 0xffff0000, v201
    v_lshlrev_b32 v196, 16, v202
    v_mfma_f32_32x32x16_bf16 v[128:143], v[60:63], a[44:47], v[128:143]
    s_waitcnt lgkmcnt(6)
    v_and_b32 v197, 0xffff0000, v202
    v_lshlrev_b32 v198, 16, v203
    v_and_b32 v199, 0xffff0000, v203
    v_lshlrev_b32 v200, 16, v204
    v_mfma_f32_32x32x16_bf16 v[80:95], v[64:67], a[48:51], v[80:95]
    s_waitcnt vmcnt(9) lgkmcnt(0)
    s_barrier
    ds_read_b64_tr_b16 v[48:49], v22 offset:32768
    ds_read_b64_tr_b16 v[50:51], v22 offset:33280
    ds_read_b128 a[64:67], v14 offset:32768
    v_mfma_f32_32x32x16_bf16 v[96:111], v[64:67], a[52:55], v[96:111]
    ds_read_b128 a[68:71], v18 offset:32768
    ds_read_b64_tr_b16 v[52:53], v22 offset:34816
    ds_read_b64_tr_b16 v[54:55], v22 offset:35328
    s_add_u32 m0, s51, 16384
    s_lshl_b32 s52, s60, 7
    s_add_u32 s52, s52, s48
    buffer_load_dwordx4 v5, s[8:11], s52 offen offset:0  lds
    v_mfma_f32_32x32x16_bf16 v[112:127], v[68:71], a[48:51], v[112:127]
    buffer_load_dwordx4 v6, s[8:11], s52 offen offset:1024  lds
    s_mul_i32 s53, s60, 172032
    v_and_b32 v201, 0xffff0000, v204
    v_lshlrev_b32 v202, 16, v205
    v_mfma_f32_32x32x16_bf16 v[128:143], v[68:71], a[52:55], v[128:143]
    buffer_load_dwordx4 v7, s[8:11], s52 offen offset:2048  lds
    s_mul_i32 s54, s60, 229376
    v_and_b32 v203, 0xffff0000, v205
    v_lshlrev_b32 v204, 16, v206
    v_mfma_f32_32x32x16_bf16 v[80:95], v[72:75], a[56:59], v[80:95]
    ds_read_b64_tr_b16 v[56:57], v22 offset:36864
    ds_read_b64_tr_b16 v[58:59], v22 offset:37376
    ds_read_b128 a[72:75], v15 offset:32768
    v_and_b32 v205, 0xffff0000, v206
    v_mfma_f32_32x32x16_bf16 v[96:111], v[72:75], a[60:63], v[96:111]
    ds_read_b128 a[76:79], v19 offset:32768
    ds_read_b64_tr_b16 v[60:61], v22 offset:38912
    ds_read_b64_tr_b16 v[62:63], v22 offset:39424
    buffer_load_dwordx4 v8, s[8:11], s52 offen offset:3072  lds
    s_add_u32 m0, s51, 65536
    s_add_u32 s53, s53, s49
    v_mfma_f32_32x32x16_bf16 v[112:127], v[76:79], a[56:59], v[112:127]
    buffer_load_dwordx4 v9, s[12:15], s53 offen offset:0  lds
    s_add_u32 s54, s54, s50
    v_lshlrev_b32 v206, 16, v207
    v_and_b32 v207, 0xffff0000, v207
    v_mfma_f32_32x32x16_bf16 v[128:143], v[76:79], a[60:63], v[128:143]
    s_waitcnt lgkmcnt(6)
    buffer_load_dwordx4 v10, s[12:15], s53 offen offset:1024  lds
    s_add_u32 m0, s51, 67584
    s_add_u32 s60, s60, 1
    s_cmp_eq_u32 s60, 7
    s_cselect_b32 s60, 0, s60
    v_mfma_f32_32x32x16_bf16 v[80:95], v[48:51], a[64:67], v[80:95]
    ds_read_b64_tr_b16 v[64:65], v22 offset:40960
    ds_read_b64_tr_b16 v[66:67], v22 offset:41472
    ds_read_b128 a[80:83], v16 offset:32768
    v_mfma_f32_32x32x16_bf16 v[96:111], v[48:51], a[68:71], v[96:111]
    ds_read_b128 a[84:87], v20 offset:32768
    ds_read_b64_tr_b16 v[68:69], v22 offset:43008
    ds_read_b64_tr_b16 v[70:71], v22 offset:43520
    buffer_load_dwordx4 v11, s[16:19], s54 offen offset:0  lds
    v_mfma_f32_32x32x16_bf16 v[112:127], v[52:55], a[64:67], v[112:127]
    buffer_load_dwordx4 v12, s[16:19], s54 offen offset:1024  lds
    v_mfma_f32_32x32x16_bf16 v[128:143], v[52:55], a[68:71], v[128:143]
    s_waitcnt lgkmcnt(6)
    s_lshr_b32 s52, s51, 2
    s_add_u32 m0, s52, 135168
    s_mul_i32 s53, s89, 172032
    s_add_u32 s53, s53, s88
    buffer_load_dwordx4 v13, s[12:15], s53 offen  lds
    s_add_u32 s89, s89, 1
    s_cmp_eq_u32 s89, 7
    s_cselect_b32 s89, 0, s89
    v_mfma_f32_32x32x16_bf16 v[80:95], v[56:59], a[72:75], v[80:95]
    ds_read_b64_tr_b16 v[72:73], v22 offset:45056
    ds_read_b64_tr_b16 v[74:75], v22 offset:45568
    ds_read_b128 a[88:91], v17 offset:32768
    v_mfma_f32_32x32x16_bf16 v[96:111], v[56:59], a[76:79], v[96:111]
    ds_read_b128 a[92:95], v21 offset:32768
    ds_read_b64_tr_b16 v[76:77], v22 offset:47104
    ds_read_b64_tr_b16 v[78:79], v22 offset:47616
    v_mfma_f32_32x32x16_bf16 v[112:127], v[60:63], a[72:75], v[112:127]
    v_mfma_f32_32x32x16_bf16 v[128:143], v[60:63], a[76:79], v[128:143]
    s_waitcnt lgkmcnt(6)
    v_mfma_f32_32x32x16_bf16 v[80:95], v[64:67], a[80:83], v[80:95]
    s_waitcnt vmcnt(10) lgkmcnt(0)
    s_barrier
    ds_read_b64_tr_b16 v[48:49], v22 offset:0
    ds_read_b64_tr_b16 v[50:51], v22 offset:512
    ds_read_b128 a[96:99], v14 offset:0
    v_mfma_f32_32x32x16_bf16 v[96:111], v[64:67], a[84:87], v[96:111]
    ds_read_b128 a[100:103], v18 offset:0
    ds_read_b64_tr_b16 v[52:53], v22 offset:2048
    ds_read_b64_tr_b16 v[54:55], v22 offset:2560
    s_add_u32 m0, s51, 32768
    s_lshl_b32 s52, s60, 7
    s_add_u32 s52, s52, s48
    buffer_load_dwordx4 v5, s[8:11], s52 offen offset:0  lds
    v_mfma_f32_32x32x16_bf16 v[112:127], v[68:71], a[80:83], v[112:127]
    buffer_load_dwordx4 v6, s[8:11], s52 offen offset:1024  lds
    s_mul_i32 s53, s60, 172032
    v_mfma_f32_32x32x16_bf16 v[128:143], v[68:71], a[84:87], v[128:143]
    buffer_load_dwordx4 v7, s[8:11], s52 offen offset:2048  lds
    s_mul_i32 s54, s60, 229376
    v_mfma_f32_32x32x16_bf16 v[80:95], v[72:75], a[88:91], v[80:95]
    ds_read_b64_tr_b16 v[56:57], v22 offset:4096
    ds_read_b64_tr_b16 v[58:59], v22 offset:4608
    ds_read_b128 a[104:107], v15 offset:0
    v_mfma_f32_32x32x16_bf16 v[96:111], v[72:75], a[92:95], v[96:111]
    ds_read_b128 a[108:111], v19 offset:0
    ds_read_b64_tr_b16 v[60:61], v22 offset:6144
    ds_read_b64_tr_b16 v[62:63], v22 offset:6656
    buffer_load_dwordx4 v8, s[8:11], s52 offen offset:3072  lds
    s_add_u32 m0, s51, 81920
    s_add_u32 s53, s53, s49
    v_mfma_f32_32x32x16_bf16 v[112:127], v[76:79], a[88:91], v[112:127]
    buffer_load_dwordx4 v9, s[12:15], s53 offen offset:0  lds
    s_add_u32 s54, s54, s50
    v_mfma_f32_32x32x16_bf16 v[128:143], v[76:79], a[92:95], v[128:143]
    s_waitcnt lgkmcnt(6)
    buffer_load_dwordx4 v10, s[12:15], s53 offen offset:1024  lds
    s_add_u32 m0, s51, 83968
    s_add_u32 s60, s60, 1
    s_cmp_eq_u32 s60, 7
    s_cselect_b32 s60, 0, s60
    v_mfma_f32_32x32x16_bf16 v[80:95], v[48:51], a[96:99], v[80:95]
    ds_read_b64_tr_b16 v[64:65], v22 offset:8192
    ds_read_b64_tr_b16 v[66:67], v22 offset:8704
    ds_read_b128 a[112:115], v16 offset:0
    v_mfma_f32_32x32x16_bf16 v[96:111], v[48:51], a[100:103], v[96:111]
    ds_read_b128 a[116:119], v20 offset:0
    ds_read_b64_tr_b16 v[68:69], v22 offset:10240
    ds_read_b64_tr_b16 v[70:71], v22 offset:10752
    buffer_load_dwordx4 v11, s[16:19], s54 offen offset:0  lds
    v_mfma_f32_32x32x16_bf16 v[112:127], v[52:55], a[96:99], v[112:127]
    v_mfma_f32_32x32x16_bf16 v[128:143], v[52:55], a[100:103], v[128:143]
    s_waitcnt lgkmcnt(6)
    buffer_load_dwordx4 v12, s[16:19], s54 offen offset:1024  lds
    v_mfma_f32_32x32x16_bf16 v[80:95], v[56:59], a[104:107], v[80:95]
    ds_read_b64_tr_b16 v[72:73], v22 offset:12288
    ds_read_b64_tr_b16 v[74:75], v22 offset:12800
    ds_read_b128 a[120:123], v17 offset:0
    v_mfma_f32_32x32x16_bf16 v[96:111], v[56:59], a[108:111], v[96:111]
    ds_read_b128 a[124:127], v21 offset:0
    ds_read_b64_tr_b16 v[76:77], v22 offset:14336
    ds_read_b64_tr_b16 v[78:79], v22 offset:14848
    v_mfma_f32_32x32x16_bf16 v[112:127], v[60:63], a[104:107], v[112:127]
    v_mfma_f32_32x32x16_bf16 v[128:143], v[60:63], a[108:111], v[128:143]
    s_waitcnt lgkmcnt(6)
    v_mfma_f32_32x32x16_bf16 v[80:95], v[64:67], a[112:115], v[80:95]
    s_waitcnt vmcnt(9) lgkmcnt(0)
    s_barrier
    ds_read_b64_tr_b16 v[48:49], v22 offset:16384
    ds_read_b64_tr_b16 v[50:51], v22 offset:16896
    ds_read_b128 a[128:131], v14 offset:16384
    v_mfma_f32_32x32x16_bf16 v[96:111], v[64:67], a[116:119], v[96:111]
    ds_read_b128 a[132:135], v18 offset:16384
    ds_read_b64_tr_b16 v[52:53], v22 offset:18432
    ds_read_b64_tr_b16 v[54:55], v22 offset:18944
    s_add_u32 m0, s51, 0
    s_lshl_b32 s52, s60, 7
    s_add_u32 s52, s52, s48
    buffer_load_dwordx4 v5, s[8:11], s52 offen offset:0  lds
    v_mfma_f32_32x32x16_bf16 v[112:127], v[68:71], a[112:115], v[112:127]
    buffer_load_dwordx4 v6, s[8:11], s52 offen offset:1024  lds
    s_mul_i32 s53, s60, 172032
    v_mfma_f32_32x32x16_bf16 v[128:143], v[68:71], a[116:119], v[128:143]
    buffer_load_dwordx4 v7, s[8:11], s52 offen offset:2048  lds
    s_mul_i32 s54, s60, 229376
    v_mfma_f32_32x32x16_bf16 v[80:95], v[72:75], a[120:123], v[80:95]
    ds_read_b64_tr_b16 v[56:57], v22 offset:20480
    ds_read_b64_tr_b16 v[58:59], v22 offset:20992
    ds_read_b128 a[136:139], v15 offset:16384
    v_mfma_f32_32x32x16_bf16 v[96:111], v[72:75], a[124:127], v[96:111]
    ds_read_b128 a[140:143], v19 offset:16384
    ds_read_b64_tr_b16 v[60:61], v22 offset:22528
    ds_read_b64_tr_b16 v[62:63], v22 offset:23040
    buffer_load_dwordx4 v8, s[8:11], s52 offen offset:3072  lds
    s_add_u32 m0, s51, 49152
    s_add_u32 s53, s53, s49
    v_mfma_f32_32x32x16_bf16 v[112:127], v[76:79], a[120:123], v[112:127]
    buffer_load_dwordx4 v9, s[12:15], s53 offen offset:0  lds
    s_add_u32 s54, s54, s50
    v_mfma_f32_32x32x16_bf16 v[128:143], v[76:79], a[124:127], v[128:143]
    s_waitcnt lgkmcnt(6)
    buffer_load_dwordx4 v10, s[12:15], s53 offen offset:1024  lds
    s_add_u32 m0, s51, 51200
    s_add_u32 s60, s60, 1
    s_cmp_eq_u32 s60, 7
    s_cselect_b32 s60, 0, s60
    v_mfma_f32_32x32x16_bf16 v[80:95], v[48:51], a[128:131], v[80:95]
    ds_read_b64_tr_b16 v[64:65], v22 offset:24576
    ds_read_b64_tr_b16 v[66:67], v22 offset:25088
    ds_read_b128 a[144:147], v16 offset:16384
    v_mfma_f32_32x32x16_bf16 v[96:111], v[48:51], a[132:135], v[96:111]
    ds_read_b128 a[148:151], v20 offset:16384
    ds_read_b64_tr_b16 v[68:69], v22 offset:26624
    ds_read_b64_tr_b16 v[70:71], v22 offset:27136
    buffer_load_dwordx4 v11, s[16:19], s54 offen offset:0  lds
    v_mfma_f32_32x32x16_bf16 v[112:127], v[52:55], a[128:131], v[112:127]
    buffer_load_dwordx4 v12, s[16:19], s54 offen offset:1024  lds
    v_mfma_f32_32x32x16_bf16 v[128:143], v[52:55], a[132:135], v[128:143]
    s_waitcnt lgkmcnt(6)
    s_lshr_b32 s52, s51, 1
    s_add_u32 m0, s52, 98304
    s_mul_i32 s54, s61, 229376
    s_add_u32 s54, s54, s50
    s_add_u32 s54, s54, 128
    buffer_load_dwordx4 v11, s[16:19], s54 offen offset:0  lds
    v_mfma_f32_32x32x16_bf16 v[80:95], v[56:59], a[136:139], v[80:95]
    ds_read_b64_tr_b16 v[72:73], v22 offset:28672
    ds_read_b64_tr_b16 v[74:75], v22 offset:29184
    ds_read_b128 a[152:155], v17 offset:16384
    v_mfma_f32_32x32x16_bf16 v[96:111], v[56:59], a[140:143], v[96:111]
    ds_read_b128 a[156:159], v21 offset:16384
    ds_read_b64_tr_b16 v[76:77], v22 offset:30720
    ds_read_b64_tr_b16 v[78:79], v22 offset:31232
    buffer_load_dwordx4 v12, s[16:19], s54 offen offset:1024  lds
    s_add_u32 s61, s61, 1
    s_cmp_eq_u32 s61, 7
    s_cselect_b32 s61, 0, s61
    v_mfma_f32_32x32x16_bf16 v[112:127], v[60:63], a[136:139], v[112:127]
    s_lshr_b32 s52, s51, 1
    s_add_u32 m0, s52, 106496
    s_mul_i32 s54, s61, 229376
    s_add_u32 s54, s54, s50
    s_add_u32 s54, s54, 128
    buffer_load_dwordx4 v11, s[16:19], s54 offen offset:0  lds
    v_mfma_f32_32x32x16_bf16 v[128:143], v[60:63], a[140:143], v[128:143]
    s_waitcnt lgkmcnt(6)
    buffer_load_dwordx4 v12, s[16:19], s54 offen offset:1024  lds
    s_add_u32 s61, s61, 1
    s_cmp_eq_u32 s61, 7
    s_cselect_b32 s61, 0, s61
    v_mfma_f32_32x32x16_bf16 v[80:95], v[64:67], a[144:147], v[80:95]
    s_waitcnt vmcnt(12) lgkmcnt(0)
    s_barrier
    ds_read_b64_tr_b16 v[48:49], v22 offset:32768
    ds_read_b64_tr_b16 v[50:51], v22 offset:33280
    ds_read_b128 a[160:163], v14 offset:32768
    v_mfma_f32_32x32x16_bf16 v[96:111], v[64:67], a[148:151], v[96:111]
    ds_read_b128 a[164:167], v18 offset:32768
    ds_read_b64_tr_b16 v[52:53], v22 offset:34816
    ds_read_b64_tr_b16 v[54:55], v22 offset:35328
    s_lshr_b32 s52, s51, 2
    s_add_u32 m0, s52, 139264
    s_mul_i32 s53, s89, 172032
    s_add_u32 s53, s53, s88
    buffer_load_dwordx4 v13, s[12:15], s53 offen  lds
    s_add_u32 s89, s89, 1
    s_cmp_eq_u32 s89, 7
    s_cselect_b32 s89, 0, s89
    v_mfma_f32_32x32x16_bf16 v[112:127], v[68:71], a[144:147], v[112:127]
    v_mfma_f32_32x32x16_bf16 v[128:143], v[68:71], a[148:151], v[128:143]
    v_mfma_f32_32x32x16_bf16 v[80:95], v[72:75], a[152:155], v[80:95]
    ds_read_b64_tr_b16 v[56:57], v22 offset:36864
    ds_read_b64_tr_b16 v[58:59], v22 offset:37376
    ds_read_b128 a[168:171], v15 offset:32768
    v_mfma_f32_32x32x16_bf16 v[96:111], v[72:75], a[156:159], v[96:111]
    ds_read_b128 a[172:175], v19 offset:32768
    ds_read_b64_tr_b16 v[60:61], v22 offset:38912
    ds_read_b64_tr_b16 v[62:63], v22 offset:39424
    s_lshr_b32 s52, s51, 2
    s_add_u32 m0, s52, 143360
    s_mul_i32 s53, s89, 172032
    s_add_u32 s53, s53, s88
    buffer_load_dwordx4 v13, s[12:15], s53 offen  lds
    s_add_u32 s89, s89, 1
    s_cmp_eq_u32 s89, 7
    s_cselect_b32 s89, 0, s89
    v_mfma_f32_32x32x16_bf16 v[112:127], v[76:79], a[152:155], v[112:127]
    v_mfma_f32_32x32x16_bf16 v[128:143], v[76:79], a[156:159], v[128:143]
    s_waitcnt lgkmcnt(6)
    v_mfma_f32_32x32x16_bf16 v[80:95], v[48:51], a[160:163], v[80:95]
    ds_read_b64_tr_b16 v[64:65], v22 offset:40960
    ds_read_b64_tr_b16 v[66:67], v22 offset:41472
    ds_read_b128 a[176:179], v16 offset:32768
    v_mfma_f32_32x32x16_bf16 v[96:111], v[48:51], a[164:167], v[96:111]
    ds_read_b128 a[180:183], v20 offset:32768
    ds_read_b64_tr_b16 v[68:69], v22 offset:43008
    ds_read_b64_tr_b16 v[70:71], v22 offset:43520
    s_lshr_b32 s52, s51, 2
    s_add_u32 m0, s52, 147456
    s_mul_i32 s53, s89, 172032
    s_add_u32 s53, s53, s88
    buffer_load_dwordx4 v13, s[12:15], s53 offen  lds
    s_add_u32 s89, s89, 1
    s_cmp_eq_u32 s89, 7
    s_cselect_b32 s89, 0, s89
    v_mfma_f32_32x32x16_bf16 v[112:127], v[52:55], a[160:163], v[112:127]
    v_mfma_f32_32x32x16_bf16 v[128:143], v[52:55], a[164:167], v[128:143]
    s_waitcnt lgkmcnt(6)
    v_mfma_f32_32x32x16_bf16 v[80:95], v[56:59], a[168:171], v[80:95]
    ds_read_b64_tr_b16 v[72:73], v22 offset:45056
    ds_read_b64_tr_b16 v[74:75], v22 offset:45568
    ds_read_b128 a[184:187], v17 offset:32768
    v_mfma_f32_32x32x16_bf16 v[96:111], v[56:59], a[172:175], v[96:111]
    ds_read_b128 a[188:191], v21 offset:32768
    ds_read_b64_tr_b16 v[76:77], v22 offset:47104
    ds_read_b64_tr_b16 v[78:79], v22 offset:47616
    s_lshr_b32 s52, s51, 2
    s_add_u32 m0, s52, 151552
    s_mul_i32 s53, s89, 172032
    s_add_u32 s53, s53, s88
    buffer_load_dwordx4 v13, s[12:15], s53 offen  lds
    s_add_u32 s89, s89, 1
    s_cmp_eq_u32 s89, 7
    s_cselect_b32 s89, 0, s89
    v_mfma_f32_32x32x16_bf16 v[112:127], v[60:63], a[168:171], v[112:127]
    v_mfma_f32_32x32x16_bf16 v[128:143], v[60:63], a[172:175], v[128:143]
    s_waitcnt lgkmcnt(6)
    v_mfma_f32_32x32x16_bf16 v[80:95], v[64:67], a[176:179], v[80:95]
    s_waitcnt vmcnt(8) lgkmcnt(0)
    s_barrier
    ds_read_b64_tr_b16 v[48:49], v22 offset:0
    ds_read_b64_tr_b16 v[50:51], v22 offset:512
    ds_read_b128 a[192:195], v14 offset:0
    v_mfma_f32_32x32x16_bf16 v[96:111], v[64:67], a[180:183], v[96:111]
    ds_read_b128 a[196:199], v18 offset:0
    ds_read_b64_tr_b16 v[52:53], v22 offset:2048
    ds_read_b64_tr_b16 v[54:55], v22 offset:2560
    s_lshr_b32 s52, s51, 2
    s_add_u32 m0, s52, 155648
    s_mul_i32 s53, s89, 172032
    s_add_u32 s53, s53, s88
    buffer_load_dwordx4 v13, s[12:15], s53 offen  lds
    s_add_u32 s89, s89, 1
    s_cmp_eq_u32 s89, 7
    s_cselect_b32 s89, 0, s89
    v_mfma_f32_32x32x16_bf16 v[112:127], v[68:71], a[176:179], v[112:127]
    v_mfma_f32_32x32x16_bf16 v[128:143], v[68:71], a[180:183], v[128:143]
    v_mfma_f32_32x32x16_bf16 v[80:95], v[72:75], a[184:187], v[80:95]
    ds_read_b64_tr_b16 v[56:57], v22 offset:4096
    ds_read_b64_tr_b16 v[58:59], v22 offset:4608
    ds_read_b128 a[200:203], v15 offset:0
    v_mfma_f32_32x32x16_bf16 v[96:111], v[72:75], a[188:191], v[96:111]
    ds_read_b128 a[204:207], v19 offset:0
    ds_read_b64_tr_b16 v[60:61], v22 offset:6144
    ds_read_b64_tr_b16 v[62:63], v22 offset:6656
    s_lshr_b32 s52, s51, 1
    s_add_u32 m0, s52, 114688
    s_mul_i32 s54, s61, 229376
    s_add_u32 s54, s54, s50
    s_add_u32 s54, s54, 128
    buffer_load_dwordx4 v11, s[16:19], s54 offen offset:0  lds
    v_mfma_f32_32x32x16_bf16 v[112:127], v[76:79], a[184:187], v[112:127]
    v_mfma_f32_32x32x16_bf16 v[128:143], v[76:79], a[188:191], v[128:143]
    s_waitcnt lgkmcnt(6)
    v_mfma_f32_32x32x16_bf16 v[80:95], v[48:51], a[192:195], v[80:95]
    ds_read_b64_tr_b16 v[64:65], v22 offset:8192
    ds_read_b64_tr_b16 v[66:67], v22 offset:8704
    ds_read_b128 a[208:211], v16 offset:0
    v_mfma_f32_32x32x16_bf16 v[96:111], v[48:51], a[196:199], v[96:111]
    ds_read_b128 a[212:215], v20 offset:0
    ds_read_b64_tr_b16 v[68:69], v22 offset:10240
    ds_read_b64_tr_b16 v[70:71], v22 offset:10752
    buffer_load_dwordx4 v12, s[16:19], s54 offen offset:1024  lds
    s_add_u32 s61, s61, 1
    s_cmp_eq_u32 s61, 7
    s_cselect_b32 s61, 0, s61
    v_mfma_f32_32x32x16_bf16 v[112:127], v[52:55], a[192:195], v[112:127]
    v_mfma_f32_32x32x16_bf16 v[128:143], v[52:55], a[196:199], v[128:143]
    s_waitcnt lgkmcnt(6)
    v_mfma_f32_32x32x16_bf16 v[80:95], v[56:59], a[200:203], v[80:95]
    ds_read_b64_tr_b16 v[72:73], v22 offset:12288
    ds_read_b64_tr_b16 v[74:75], v22 offset:12800
    ds_read_b128 a[216:219], v17 offset:0
    v_mfma_f32_32x32x16_bf16 v[96:111], v[56:59], a[204:207], v[96:111]
    ds_read_b128 a[220:223], v21 offset:0
    ds_read_b64_tr_b16 v[76:77], v22 offset:14336
    ds_read_b64_tr_b16 v[78:79], v22 offset:14848
    v_mfma_f32_32x32x16_bf16 v[112:127], v[60:63], a[200:203], v[112:127]
    v_mfma_f32_32x32x16_bf16 v[128:143], v[60:63], a[204:207], v[128:143]
    s_waitcnt lgkmcnt(6)
    v_mfma_f32_32x32x16_bf16 v[80:95], v[64:67], a[208:211], v[80:95]
    v_mfma_f32_32x32x16_bf16 v[96:111], v[64:67], a[212:215], v[96:111]
    v_mfma_f32_32x32x16_bf16 v[112:127], v[68:71], a[208:211], v[112:127]
    v_mfma_f32_32x32x16_bf16 v[128:143], v[68:71], a[212:215], v[128:143]
    s_waitcnt lgkmcnt(0)
    v_mfma_f32_32x32x16_bf16 v[80:95], v[72:75], a[216:219], v[80:95]
    v_mfma_f32_32x32x16_bf16 v[96:111], v[72:75], a[220:223], v[96:111]
    v_mfma_f32_32x32x16_bf16 v[112:127], v[76:79], a[216:219], v[112:127]
    v_mfma_f32_32x32x16_bf16 v[128:143], v[76:79], a[220:223], v[128:143]
    s_branch L_p1done
L_p1v:
    s_waitcnt lgkmcnt(9)
    v_mfma_f32_32x32x16_bf16 v[80:95], a[0:3], v[48:51], 0
    ds_read_b64_tr_b16 v[64:65], v22 offset:8192
    ds_read_b64_tr_b16 v[66:67], v22 offset:8704
    ds_read_b128 a[16:19], v16 offset:0
    s_add_u32 m0, s51, 32768
    s_lshl_b32 s52, s60, 7
    s_add_u32 s52, s52, s48
    buffer_load_dwordx4 v5, s[8:11], s52 offen offset:0  lds
    s_waitcnt lgkmcnt(11)
    v_mfma_f32_32x32x16_bf16 v[96:111], a[4:7], v[48:51], 0
    ds_read_b128 a[20:23], v20 offset:0
    ds_read_b64_tr_b16 v[68:69], v22 offset:10240
    ds_read_b64_tr_b16 v[70:71], v22 offset:10752
    buffer_load_dwordx4 v6, s[8:11], s52 offen offset:1024  lds
    s_mul_i32 s53, s60, 172032
    s_waitcnt lgkmcnt(12)
    v_mfma_f32_32x32x16_bf16 v[112:127], v[52:55], a[0:3], v[224:239]
    buffer_load_dwordx4 v7, s[8:11], s52 offen offset:2048  lds
    s_mul_i32 s54, s60, 229376
    s_xor_b32 s45, s69, 1
    s_lshl2_add_u32 s46, s6, s63
    v_mfma_f32_32x32x16_bf16 v[128:143], v[52:55], a[4:7], v[224:239]
    s_waitcnt lgkmcnt(6)
    buffer_load_dwordx4 v8, s[8:11], s52 offen offset:3072  lds
    s_add_u32 m0, s51, 81920
    s_add_u32 s53, s53, s49
    s_lshl_b32 s46, s46, 11
    s_add_u32 s46, s46, 0x634000
    v_mfma_f32_32x32x16_bf16 v[80:95], a[8:11], v[56:59], v[80:95]
    ds_read_b64_tr_b16 v[72:73], v22 offset:12288
    ds_read_b64_tr_b16 v[74:75], v22 offset:12800
    ds_read_b128 a[24:27], v17 offset:0
    buffer_load_dwordx4 v9, s[12:15], s53 offen offset:0  lds
    s_add_u32 s54, s54, s50
    v_mfma_f32_32x32x16_bf16 v[96:111], a[12:15], v[56:59], v[96:111]
    ds_read_b128 a[28:31], v21 offset:0
    ds_read_b64_tr_b16 v[76:77], v22 offset:14336
    ds_read_b64_tr_b16 v[78:79], v22 offset:14848
    buffer_load_dwordx4 v10, s[12:15], s53 offen offset:1024  lds
    s_add_u32 m0, s51, 83968
    s_add_u32 s60, s60, 1
    s_cmp_eq_u32 s60, 7
    s_cselect_b32 s60, 0, s60
    v_mfma_f32_32x32x16_bf16 v[112:127], v[60:63], a[8:11], v[112:127]
    buffer_load_dwordx4 v11, s[16:19], s54 offen offset:0  lds
    s_mul_i32 s58, s69, 135168
    s_add_u32 s58, s58, s46
    v_mfma_f32_32x32x16_bf16 v[128:143], v[60:63], a[12:15], v[128:143]
    s_waitcnt lgkmcnt(6)
    buffer_load_dwordx4 v12, s[16:19], s54 offen offset:1024  lds
    s_mul_i32 s59, s45, 135168
    s_add_u32 s59, s59, s46
    v_mfma_f32_32x32x16_bf16 v[80:95], a[16:19], v[64:67], v[80:95]
    s_waitcnt vmcnt(8) lgkmcnt(0)
    s_barrier
    ds_read_b64_tr_b16 v[48:49], v22 offset:16384
    ds_read_b64_tr_b16 v[50:51], v22 offset:16896
    ds_read_b128 a[32:35], v14 offset:16384
    v_mfma_f32_32x32x16_bf16 v[96:111], a[20:23], v[64:67], v[96:111]
    ds_read_b128 a[36:39], v18 offset:16384
    ds_read_b64_tr_b16 v[52:53], v22 offset:18432
    ds_read_b64_tr_b16 v[54:55], v22 offset:18944
    s_add_u32 m0, s51, 0
    s_lshl_b32 s52, s60, 7
    s_add_u32 s52, s52, s48
    buffer_load_dwordx4 v5, s[8:11], s52 offen offset:0  lds
    v_mfma_f32_32x32x16_bf16 v[112:127], v[68:71], a[16:19], v[112:127]
    buffer_load_dwordx4 v6, s[8:11], s52 offen offset:1024  lds
    s_mul_i32 s53, s60, 172032
    s_cmp_eq_u32 s4, 0
    s_cselect_b32 s46, 0, 0x40000000
    v_mfma_f32_32x32x16_bf16 v[128:143], v[68:71], a[20:23], v[128:143]
    buffer_load_dwordx4 v7, s[8:11], s52 offen offset:2048  lds
    s_mul_i32 s54, s60, 229376
    s_lshl_b32 s83, s69, 7
    s_add_u32 s83, s83, s46
    v_mfma_f32_32x32x16_bf16 v[80:95], a[24:27], v[72:75], v[80:95]
    ds_read_b64_tr_b16 v[56:57], v22 offset:20480
    ds_read_b64_tr_b16 v[58:59], v22 offset:20992
    ds_read_b128 a[40:43], v15 offset:16384
    s_add_u32 s83, s83, 0x4000
    v_mfma_f32_32x32x16_bf16 v[96:111], a[28:31], v[72:75], v[96:111]
    ds_read_b128 a[44:47], v19 offset:16384
    ds_read_b64_tr_b16 v[60:61], v22 offset:22528
    ds_read_b64_tr_b16 v[62:63], v22 offset:23040
    buffer_load_dwordx4 v8, s[8:11], s52 offen offset:3072  lds
    s_add_u32 m0, s51, 49152
    s_add_u32 s53, s53, s49
    v_mfma_f32_32x32x16_bf16 v[112:127], v[76:79], a[24:27], v[112:127]
    buffer_load_dwordx4 v9, s[12:15], s53 offen offset:0  lds
    s_add_u32 s54, s54, s50
    v_and_b32 v44, 0x13, v42
    v_and_b32 v43, 4, v42
    v_mfma_f32_32x32x16_bf16 v[128:143], v[76:79], a[28:31], v[128:143]
    s_waitcnt lgkmcnt(6)
    buffer_load_dwordx4 v10, s[12:15], s53 offen offset:1024  lds
    s_add_u32 m0, s51, 51200
    s_add_u32 s60, s60, 1
    s_cmp_eq_u32 s60, 7
    s_cselect_b32 s60, 0, s60
    v_lshl_add_u32 v44, v43, 1, v44
    v_bfe_u32 v43, v42, 3, 1
    v_mfma_f32_32x32x16_bf16 v[80:95], a[32:35], v[48:51], v[80:95]
    ds_read_b64_tr_b16 v[64:65], v22 offset:24576
    ds_read_b64_tr_b16 v[66:67], v22 offset:25088
    ds_read_b128 a[48:51], v16 offset:16384
    v_lshl_add_u32 v44, v43, 2, v44
    v_mfma_f32_32x32x16_bf16 v[96:111], a[36:39], v[48:51], v[96:111]
    ds_read_b128 a[52:55], v20 offset:16384
    ds_read_b64_tr_b16 v[68:69], v22 offset:26624
    ds_read_b64_tr_b16 v[70:71], v22 offset:27136
    buffer_load_dwordx4 v11, s[16:19], s54 offen offset:0  lds
    v_mfma_f32_32x32x16_bf16 v[112:127], v[52:55], a[32:35], v[112:127]
    buffer_load_dwordx4 v12, s[16:19], s54 offen offset:1024  lds
    s_sub_u32 s46, s6, 7
    s_lshl1_add_u32 s46, s46, s63
    v_mfma_f32_32x32x16_bf16 v[128:143], v[52:55], a[36:39], v[128:143]
    s_waitcnt lgkmcnt(6)
    s_lshr_b32 s52, s51, 2
    s_add_u32 m0, s52, 131072
    s_mul_i32 s53, s89, 172032
    s_add_u32 s53, s53, s88
    buffer_load_dwordx4 v13, s[12:15], s53 offen  lds
    s_add_u32 s89, s89, 1
    s_cmp_eq_u32 s89, 7
    s_cselect_b32 s89, 0, s89
    s_lshl_b32 s46, s46, 5
    v_add_u32 v44, s46, v44
    v_mfma_f32_32x32x16_bf16 v[80:95], a[40:43], v[56:59], v[80:95]
    ds_read_b64_tr_b16 v[72:73], v22 offset:28672
    ds_read_b64_tr_b16 v[74:75], v22 offset:29184
    ds_read_b128 a[56:59], v17 offset:16384
    v_mul_u32_u24 v45, 2341, v44
    v_mfma_f32_32x32x16_bf16 v[96:111], a[44:47], v[56:59], v[96:111]
    ds_read_b128 a[60:63], v21 offset:16384
    ds_read_b64_tr_b16 v[76:77], v22 offset:30720
    ds_read_b64_tr_b16 v[78:79], v22 offset:31232
    v_lshrrev_b32 v45, 16, v45
    v_mfma_f32_32x32x16_bf16 v[112:127], v[60:63], a[40:43], v[112:127]
    v_mul_u32_u24 v47, 28, v45
    v_sub_u32 v47, v44, v47
    v_and_b32 v44, 0x13, v47
    v_and_b32 v43, 4, v47
    v_mfma_f32_32x32x16_bf16 v[128:143], v[60:63], a[44:47], v[128:143]
    s_waitcnt lgkmcnt(6)
    v_lshl_add_u32 v44, v43, 1, v44
    v_bfe_u32 v43, v47, 3, 1
    v_lshl_add_u32 v44, v43, 2, v44
    v_lshlrev_b32 v24, 4, v44
    v_mfma_f32_32x32x16_bf16 v[80:95], a[48:51], v[64:67], v[80:95]
    s_waitcnt vmcnt(9) lgkmcnt(0)
    s_barrier
    ds_read_b64_tr_b16 v[48:49], v22 offset:32768
    ds_read_b64_tr_b16 v[50:51], v22 offset:33280
    ds_read_b128 a[64:67], v14 offset:32768
    v_mfma_f32_32x32x16_bf16 v[96:111], a[52:55], v[64:67], v[96:111]
    ds_read_b128 a[68:71], v18 offset:32768
    ds_read_b64_tr_b16 v[52:53], v22 offset:34816
    ds_read_b64_tr_b16 v[54:55], v22 offset:35328
    s_add_u32 m0, s51, 16384
    s_lshl_b32 s52, s60, 7
    s_add_u32 s52, s52, s48
    buffer_load_dwordx4 v5, s[8:11], s52 offen offset:0  lds
    v_mfma_f32_32x32x16_bf16 v[112:127], v[68:71], a[48:51], v[112:127]
    buffer_load_dwordx4 v6, s[8:11], s52 offen offset:1024  lds
    s_mul_i32 s53, s60, 172032
    v_lshl_add_u32 v24, v41, 9, v24
    v_lshl_add_u32 v24, v45, 17, v24
    v_mfma_f32_32x32x16_bf16 v[128:143], v[68:71], a[52:55], v[128:143]
    buffer_load_dwordx4 v7, s[8:11], s52 offen offset:2048  lds
    s_mul_i32 s54, s60, 229376
    s_lshl_b32 s56, s69, 11
    s_add_u32 s56, s56, 0x220000
    v_mfma_f32_32x32x16_bf16 v[80:95], a[56:59], v[72:75], v[80:95]
    ds_read_b64_tr_b16 v[56:57], v22 offset:36864
    ds_read_b64_tr_b16 v[58:59], v22 offset:37376
    ds_read_b128 a[72:75], v15 offset:32768
    s_xor_b32 s57, s56, 0x800
    v_mfma_f32_32x32x16_bf16 v[96:111], a[60:63], v[72:75], v[96:111]
    ds_read_b128 a[76:79], v19 offset:32768
    ds_read_b64_tr_b16 v[60:61], v22 offset:38912
    ds_read_b64_tr_b16 v[62:63], v22 offset:39424
    buffer_load_dwordx4 v8, s[8:11], s52 offen offset:3072  lds
    s_add_u32 m0, s51, 65536
    s_add_u32 s53, s53, s49
    v_mfma_f32_32x32x16_bf16 v[112:127], v[76:79], a[56:59], v[112:127]
    buffer_load_dwordx4 v9, s[12:15], s53 offen offset:0  lds
    s_add_u32 s54, s54, s50
    s_mov_b32 s44, 0x9e3779b1
    v_mul_lo_u32 v3, s44, v3
    v_mfma_f32_32x32x16_bf16 v[128:143], v[76:79], a[60:63], v[128:143]
    s_waitcnt lgkmcnt(6)
    buffer_load_dwordx4 v10, s[12:15], s53 offen offset:1024  lds
    s_add_u32 m0, s51, 67584
    s_add_u32 s60, s60, 1
    s_cmp_eq_u32 s60, 7
    s_cselect_b32 s60, 0, s60
    v_xor_b32 v3, 0x5bd1e995, v3
    v_lshlrev_b32 v192, 16, v200
    v_mfma_f32_32x32x16_bf16 v[80:95], a[64:67], v[48:51], v[80:95]
    ds_read_b64_tr_b16 v[64:65], v22 offset:40960
    ds_read_b64_tr_b16 v[66:67], v22 offset:41472
    ds_read_b128 a[80:83], v16 offset:32768
    v_and_b32 v193, 0xffff0000, v200
    v_mfma_f32_32x32x16_bf16 v[96:111], a[68:71], v[48:51], v[96:111]
    ds_read_b128 a[84:87], v20 offset:32768
    ds_read_b64_tr_b16 v[68:69], v22 offset:43008
    ds_read_b64_tr_b16 v[70:71], v22 offset:43520
    buffer_load_dwordx4 v11, s[16:19], s54 offen offset:0  lds
    v_mfma_f32_32x32x16_bf16 v[112:127], v[52:55], a[64:67], v[112:127]
    buffer_load_dwordx4 v12, s[16:19], s54 offen offset:1024  lds
    v_lshlrev_b32 v194, 16, v201
    v_and_b32 v195, 0xffff0000, v201
    v_mfma_f32_32x32x16_bf16 v[128:143], v[52:55], a[68:71], v[128:143]
    s_waitcnt lgkmcnt(6)
    s_lshr_b32 s52, s51, 2
    s_add_u32 m0, s52, 135168
    s_mul_i32 s53, s89, 172032
    s_add_u32 s53, s53, s88
    buffer_load_dwordx4 v13, s[12:15], s53 offen  lds
    s_add_u32 s89, s89, 1
    s_cmp_eq_u32 s89, 7
    s_cselect_b32 s89, 0, s89
    v_lshlrev_b32 v196, 16, v202
    v_and_b32 v197, 0xffff0000, v202
    v_mfma_f32_32x32x16_bf16 v[80:95], a[72:75], v[56:59], v[80:95]
    ds_read_b64_tr_b16 v[72:73], v22 offset:45056
    ds_read_b64_tr_b16 v[74:75], v22 offset:45568
    ds_read_b128 a[88:91], v17 offset:32768
    v_lshlrev_b32 v198, 16, v203
    v_mfma_f32_32x32x16_bf16 v[96:111], a[76:79], v[56:59], v[96:111]
    ds_read_b128 a[92:95], v21 offset:32768
    ds_read_b64_tr_b16 v[76:77], v22 offset:47104
    ds_read_b64_tr_b16 v[78:79], v22 offset:47616
    v_and_b32 v199, 0xffff0000, v203
    v_mfma_f32_32x32x16_bf16 v[112:127], v[60:63], a[72:75], v[112:127]
    v_lshlrev_b32 v200, 16, v204
    v_and_b32 v201, 0xffff0000, v204
    v_lshlrev_b32 v202, 16, v205
    v_and_b32 v203, 0xffff0000, v205
    v_mfma_f32_32x32x16_bf16 v[128:143], v[60:63], a[76:79], v[128:143]
    s_waitcnt lgkmcnt(6)
    v_lshlrev_b32 v204, 16, v206
    v_and_b32 v205, 0xffff0000, v206
    v_lshlrev_b32 v206, 16, v207
    v_and_b32 v207, 0xffff0000, v207
    v_mfma_f32_32x32x16_bf16 v[80:95], a[80:83], v[64:67], v[80:95]
    s_waitcnt vmcnt(10) lgkmcnt(0)
    s_barrier
    ds_read_b64_tr_b16 v[48:49], v22 offset:0
    ds_read_b64_tr_b16 v[50:51], v22 offset:512
    ds_read_b128 a[96:99], v14 offset:0
    v_mfma_f32_32x32x16_bf16 v[96:111], a[84:87], v[64:67], v[96:111]
    ds_read_b128 a[100:103], v18 offset:0
    ds_read_b64_tr_b16 v[52:53], v22 offset:2048
    ds_read_b64_tr_b16 v[54:55], v22 offset:2560
    s_add_u32 m0, s51, 32768
    s_lshl_b32 s52, s60, 7
    s_add_u32 s52, s52, s48
    buffer_load_dwordx4 v5, s[8:11], s52 offen offset:0  lds
    v_mfma_f32_32x32x16_bf16 v[112:127], v[68:71], a[80:83], v[112:127]
    buffer_load_dwordx4 v6, s[8:11], s52 offen offset:1024  lds
    s_mul_i32 s53, s60, 172032
    v_mfma_f32_32x32x16_bf16 v[128:143], v[68:71], a[84:87], v[128:143]
    buffer_load_dwordx4 v7, s[8:11], s52 offen offset:2048  lds
    s_mul_i32 s54, s60, 229376
    v_mfma_f32_32x32x16_bf16 v[80:95], a[88:91], v[72:75], v[80:95]
    ds_read_b64_tr_b16 v[56:57], v22 offset:4096
    ds_read_b64_tr_b16 v[58:59], v22 offset:4608
    ds_read_b128 a[104:107], v15 offset:0
    v_mfma_f32_32x32x16_bf16 v[96:111], a[92:95], v[72:75], v[96:111]
    ds_read_b128 a[108:111], v19 offset:0
    ds_read_b64_tr_b16 v[60:61], v22 offset:6144
    ds_read_b64_tr_b16 v[62:63], v22 offset:6656
    buffer_load_dwordx4 v8, s[8:11], s52 offen offset:3072  lds
    s_add_u32 m0, s51, 81920
    s_add_u32 s53, s53, s49
    v_mfma_f32_32x32x16_bf16 v[112:127], v[76:79], a[88:91], v[112:127]
    buffer_load_dwordx4 v9, s[12:15], s53 offen offset:0  lds
    s_add_u32 s54, s54, s50
    v_mfma_f32_32x32x16_bf16 v[128:143], v[76:79], a[92:95], v[128:143]
    s_waitcnt lgkmcnt(6)
    buffer_load_dwordx4 v10, s[12:15], s53 offen offset:1024  lds
    s_add_u32 m0, s51, 83968
    s_add_u32 s60, s60, 1
    s_cmp_eq_u32 s60, 7
    s_cselect_b32 s60, 0, s60
    v_mfma_f32_32x32x16_bf16 v[80:95], a[96:99], v[48:51], v[80:95]
    ds_read_b64_tr_b16 v[64:65], v22 offset:8192
    ds_read_b64_tr_b16 v[66:67], v22 offset:8704
    ds_read_b128 a[112:115], v16 offset:0
    v_mfma_f32_32x32x16_bf16 v[96:111], a[100:103], v[48:51], v[96:111]
    ds_read_b128 a[116:119], v20 offset:0
    ds_read_b64_tr_b16 v[68:69], v22 offset:10240
    ds_read_b64_tr_b16 v[70:71], v22 offset:10752
    buffer_load_dwordx4 v11, s[16:19], s54 offen offset:0  lds
    v_mfma_f32_32x32x16_bf16 v[112:127], v[52:55], a[96:99], v[112:127]
    v_mfma_f32_32x32x16_bf16 v[128:143], v[52:55], a[100:103], v[128:143]
    s_waitcnt lgkmcnt(6)
    buffer_load_dwordx4 v12, s[16:19], s54 offen offset:1024  lds
    v_mfma_f32_32x32x16_bf16 v[80:95], a[104:107], v[56:59], v[80:95]
    ds_read_b64_tr_b16 v[72:73], v22 offset:12288
    ds_read_b64_tr_b16 v[74:75], v22 offset:12800
    ds_read_b128 a[120:123], v17 offset:0
    v_mfma_f32_32x32x16_bf16 v[96:111], a[108:111], v[56:59], v[96:111]
    ds_read_b128 a[124:127], v21 offset:0
    ds_read_b64_tr_b16 v[76:77], v22 offset:14336
    ds_read_b64_tr_b16 v[78:79], v22 offset:14848
    v_mfma_f32_32x32x16_bf16 v[112:127], v[60:63], a[104:107], v[112:127]
    v_mfma_f32_32x32x16_bf16 v[128:143], v[60:63], a[108:111], v[128:143]
    s_waitcnt lgkmcnt(6)
    v_mfma_f32_32x32x16_bf16 v[80:95], a[112:115], v[64:67], v[80:95]
    s_waitcnt vmcnt(9) lgkmcnt(0)
    s_barrier
    ds_read_b64_tr_b16 v[48:49], v22 offset:16384
    ds_read_b64_tr_b16 v[50:51], v22 offset:16896
    ds_read_b128 a[128:131], v14 offset:16384
    v_mfma_f32_32x32x16_bf16 v[96:111], a[116:119], v[64:67], v[96:111]
    ds_read_b128 a[132:135], v18 offset:16384
    ds_read_b64_tr_b16 v[52:53], v22 offset:18432
    ds_read_b64_tr_b16 v[54:55], v22 offset:18944
    s_add_u32 m0, s51, 0
    s_lshl_b32 s52, s60, 7
    s_add_u32 s52, s52, s48
    buffer_load_dwordx4 v5, s[8:11], s52 offen offset:0  lds
    v_mfma_f32_32x32x16_bf16 v[112:127], v[68:71], a[112:115], v[112:127]
    buffer_load_dwordx4 v6, s[8:11], s52 offen offset:1024  lds
    s_mul_i32 s53, s60, 172032
    v_mfma_f32_32x32x16_bf16 v[128:143], v[68:71], a[116:119], v[128:143]
    buffer_load_dwordx4 v7, s[8:11], s52 offen offset:2048  lds
    s_mul_i32 s54, s60, 229376
    v_mfma_f32_32x32x16_bf16 v[80:95], a[120:123], v[72:75], v[80:95]
    ds_read_b64_tr_b16 v[56:57], v22 offset:20480
    ds_read_b64_tr_b16 v[58:59], v22 offset:20992
    ds_read_b128 a[136:139], v15 offset:16384
    v_mfma_f32_32x32x16_bf16 v[96:111], a[124:127], v[72:75], v[96:111]
    ds_read_b128 a[140:143], v19 offset:16384
    ds_read_b64_tr_b16 v[60:61], v22 offset:22528
    ds_read_b64_tr_b16 v[62:63], v22 offset:23040
    buffer_load_dwordx4 v8, s[8:11], s52 offen offset:3072  lds
    s_add_u32 m0, s51, 49152
    s_add_u32 s53, s53, s49
    v_mfma_f32_32x32x16_bf16 v[112:127], v[76:79], a[120:123], v[112:127]
    buffer_load_dwordx4 v9, s[12:15], s53 offen offset:0  lds
    s_add_u32 s54, s54, s50
    v_mfma_f32_32x32x16_bf16 v[128:143], v[76:79], a[124:127], v[128:143]
    s_waitcnt lgkmcnt(6)
    buffer_load_dwordx4 v10, s[12:15], s53 offen offset:1024  lds
    s_add_u32 m0, s51, 51200
    s_add_u32 s60, s60, 1
    s_cmp_eq_u32 s60, 7
    s_cselect_b32 s60, 0, s60
    v_mfma_f32_32x32x16_bf16 v[80:95], a[128:131], v[48:51], v[80:95]
    ds_read_b64_tr_b16 v[64:65], v22 offset:24576
    ds_read_b64_tr_b16 v[66:67], v22 offset:25088
    ds_read_b128 a[144:147], v16 offset:16384
    v_mfma_f32_32x32x16_bf16 v[96:111], a[132:135], v[48:51], v[96:111]
    ds_read_b128 a[148:151], v20 offset:16384
    ds_read_b64_tr_b16 v[68:69], v22 offset:26624
    ds_read_b64_tr_b16 v[70:71], v22 offset:27136
    buffer_load_dwordx4 v11, s[16:19], s54 offen offset:0  lds
    v_mfma_f32_32x32x16_bf16 v[112:127], v[52:55], a[128:131], v[112:127]
    buffer_load_dwordx4 v12, s[16:19], s54 offen offset:1024  lds
    v_mfma_f32_32x32x16_bf16 v[128:143], v[52:55], a[132:135], v[128:143]
    s_waitcnt lgkmcnt(6)
    s_lshr_b32 s52, s51, 1
    s_add_u32 m0, s52, 98304
    s_mul_i32 s54, s61, 229376
    s_add_u32 s54, s54, s50
    s_add_u32 s54, s54, 128
    buffer_load_dwordx4 v11, s[16:19], s54 offen offset:0  lds
    v_mfma_f32_32x32x16_bf16 v[80:95], a[136:139], v[56:59], v[80:95]
    ds_read_b64_tr_b16 v[72:73], v22 offset:28672
    ds_read_b64_tr_b16 v[74:75], v22 offset:29184
    ds_read_b128 a[152:155], v17 offset:16384
    v_mfma_f32_32x32x16_bf16 v[96:111], a[140:143], v[56:59], v[96:111]
    ds_read_b128 a[156:159], v21 offset:16384
    ds_read_b64_tr_b16 v[76:77], v22 offset:30720
    ds_read_b64_tr_b16 v[78:79], v22 offset:31232
    buffer_load_dwordx4 v12, s[16:19], s54 offen offset:1024  lds
    s_add_u32 s61, s61, 1
    s_cmp_eq_u32 s61, 7
    s_cselect_b32 s61, 0, s61
    v_mfma_f32_32x32x16_bf16 v[112:127], v[60:63], a[136:139], v[112:127]
    s_lshr_b32 s52, s51, 1
    s_add_u32 m0, s52, 106496
    s_mul_i32 s54, s61, 229376
    s_add_u32 s54, s54, s50
    s_add_u32 s54, s54, 128
    buffer_load_dwordx4 v11, s[16:19], s54 offen offset:0  lds
    v_mfma_f32_32x32x16_bf16 v[128:143], v[60:63], a[140:143], v[128:143]
    s_waitcnt lgkmcnt(6)
    buffer_load_dwordx4 v12, s[16:19], s54 offen offset:1024  lds
    s_add_u32 s61, s61, 1
    s_cmp_eq_u32 s61, 7
    s_cselect_b32 s61, 0, s61
    v_mfma_f32_32x32x16_bf16 v[80:95], a[144:147], v[64:67], v[80:95]
    s_waitcnt vmcnt(12) lgkmcnt(0)
    s_barrier
    ds_read_b64_tr_b16 v[48:49], v22 offset:32768
    ds_read_b64_tr_b16 v[50:51], v22 offset:33280
    ds_read_b128 a[160:163], v14 offset:32768
    v_mfma_f32_32x32x16_bf16 v[96:111], a[148:151], v[64:67], v[96:111]
    ds_read_b128 a[164:167], v18 offset:32768
    ds_read_b64_tr_b16 v[52:53], v22 offset:34816
    ds_read_b64_tr_b16 v[54:55], v22 offset:35328
    s_lshr_b32 s52, s51, 2
    s_add_u32 m0, s52, 139264
    s_mul_i32 s53, s89, 172032
    s_add_u32 s53, s53, s88
    buffer_load_dwordx4 v13, s[12:15], s53 offen  lds
    s_add_u32 s89, s89, 1
    s_cmp_eq_u32 s89, 7
    s_cselect_b32 s89, 0, s89
    v_mfma_f32_32x32x16_bf16 v[112:127], v[68:71], a[144:147], v[112:127]
    v_mfma_f32_32x32x16_bf16 v[128:143], v[68:71], a[148:151], v[128:143]
    v_mfma_f32_32x32x16_bf16 v[80:95], a[152:155], v[72:75], v[80:95]
    ds_read_b64_tr_b16 v[56:57], v22 offset:36864
    ds_read_b64_tr_b16 v[58:59], v22 offset:37376
    ds_read_b128 a[168:171], v15 offset:32768
    v_mfma_f32_32x32x16_bf16 v[96:111], a[156:159], v[72:75], v[96:111]
    ds_read_b128 a[172:175], v19 offset:32768
    ds_read_b64_tr_b16 v[60:61], v22 offset:38912
    ds_read_b64_tr_b16 v[62:63], v22 offset:39424
    s_lshr_b32 s52, s51, 2
    s_add_u32 m0, s52, 143360
    s_mul_i32 s53, s89, 172032
    s_add_u32 s53, s53, s88
    buffer_load_dwordx4 v13, s[12:15], s53 offen  lds
    s_add_u32 s89, s89, 1
    s_cmp_eq_u32 s89, 7
    s_cselect_b32 s89, 0, s89
    v_mfma_f32_32x32x16_bf16 v[112:127], v[76:79], a[152:155], v[112:127]
    v_mfma_f32_32x32x16_bf16 v[128:143], v[76:79], a[156:159], v[128:143]
    s_waitcnt lgkmcnt(6)
    v_mfma_f32_32x32x16_bf16 v[80:95], a[160:163], v[48:51], v[80:95]
    ds_read_b64_tr_b16 v[64:65], v22 offset:40960
    ds_read_b64_tr_b16 v[66:67], v22 offset:41472
    ds_read_b128 a[176:179], v16 offset:32768
    v_mfma_f32_32x32x16_bf16 v[96:111], a[164:167], v[48:51], v[96:111]
    ds_read_b128 a[180:183], v20 offset:32768
    ds_read_b64_tr_b16 v[68:69], v22 offset:43008
    ds_read_b64_tr_b16 v[70:71], v22 offset:43520
    s_lshr_b32 s52, s51, 2
    s_add_u32 m0, s52, 147456
    s_mul_i32 s53, s89, 172032
    s_add_u32 s53, s53, s88
    buffer_load_dwordx4 v13, s[12:15], s53 offen  lds
    s_add_u32 s89, s89, 1
    s_cmp_eq_u32 s89, 7
    s_cselect_b32 s89, 0, s89
    v_mfma_f32_32x32x16_bf16 v[112:127], v[52:55], a[160:163], v[112:127]
    v_mfma_f32_32x32x16_bf16 v[128:143], v[52:55], a[164:167], v[128:143]
    s_waitcnt lgkmcnt(6)
    v_mfma_f32_32x32x16_bf16 v[80:95], a[168:171], v[56:59], v[80:95]
    ds_read_b64_tr_b16 v[72:73], v22 offset:45056
    ds_read_b64_tr_b16 v[74:75], v22 offset:45568
    ds_read_b128 a[184:187], v17 offset:32768
    v_mfma_f32_32x32x16_bf16 v[96:111], a[172:175], v[56:59], v[96:111]
    ds_read_b128 a[188:191], v21 offset:32768
    ds_read_b64_tr_b16 v[76:77], v22 offset:47104
    ds_read_b64_tr_b16 v[78:79], v22 offset:47616
    s_lshr_b32 s52, s51, 2
    s_add_u32 m0, s52, 151552
    s_mul_i32 s53, s89, 172032
    s_add_u32 s53, s53, s88
    buffer_load_dwordx4 v13, s[12:15], s53 offen  lds
    s_add_u32 s89, s89, 1
    s_cmp_eq_u32 s89, 7
    s_cselect_b32 s89, 0, s89
    v_mfma_f32_32x32x16_bf16 v[112:127], v[60:63], a[168:171], v[112:127]
    v_mfma_f32_32x32x16_bf16 v[128:143], v[60:63], a[172:175], v[128:143]
    s_waitcnt lgkmcnt(6)
    v_mfma_f32_32x32x16_bf16 v[80:95], a[176:179], v[64:67], v[80:95]
    s_waitcnt vmcnt(8) lgkmcnt(0)
    s_barrier
    ds_read_b64_tr_b16 v[48:49], v22 offset:0
    ds_read_b64_tr_b16 v[50:51], v22 offset:512
    ds_read_b128 a[192:195], v14 offset:0
    v_mfma_f32_32x32x16_bf16 v[96:111], a[180:183], v[64:67], v[96:111]
    ds_read_b128 a[196:199], v18 offset:0
    ds_read_b64_tr_b16 v[52:53], v22 offset:2048
    ds_read_b64_tr_b16 v[54:55], v22 offset:2560
    s_lshr_b32 s52, s51, 2
    s_add_u32 m0, s52, 155648
    s_mul_i32 s53, s89, 172032
    s_add_u32 s53, s53, s88
    buffer_load_dwordx4 v13, s[12:15], s53 offen  lds
    s_add_u32 s89, s89, 1
    s_cmp_eq_u32 s89, 7
    s_cselect_b32 s89, 0, s89
    v_mfma_f32_32x32x16_bf16 v[112:127], v[68:71], a[176:179], v[112:127]
    v_mfma_f32_32x32x16_bf16 v[128:143], v[68:71], a[180:183], v[128:143]
    v_mfma_f32_32x32x16_bf16 v[80:95], a[184:187], v[72:75], v[80:95]
    ds_read_b64_tr_b16 v[56:57], v22 offset:4096
    ds_read_b64_tr_b16 v[58:59], v22 offset:4608
    ds_read_b128 a[200:203], v15 offset:0
    v_mfma_f32_32x32x16_bf16 v[96:111], a[188:191], v[72:75], v[96:111]
    ds_read_b128 a[204:207], v19 offset:0
    ds_read_b64_tr_b16 v[60:61], v22 offset:6144
    ds_read_b64_tr_b16 v[62:63], v22 offset:6656
    s_lshr_b32 s52, s51, 1
    s_add_u32 m0, s52, 114688
    s_mul_i32 s54, s61, 229376
    s_add_u32 s54, s54, s50
    s_add_u32 s54, s54, 128
    buffer_load_dwordx4 v11, s[16:19], s54 offen offset:0  lds
    v_mfma_f32_32x32x16_bf16 v[112:127], v[76:79], a[184:187], v[112:127]
    v_mfma_f32_32x32x16_bf16 v[128:143], v[76:79], a[188:191], v[128:143]
    s_waitcnt lgkmcnt(6)
    v_mfma_f32_32x32x16_bf16 v[80:95], a[192:195], v[48:51], v[80:95]
    ds_read_b64_tr_b16 v[64:65], v22 offset:8192
    ds_read_b64_tr_b16 v[66:67], v22 offset:8704
    ds_read_b128 a[208:211], v16 offset:0
    v_mfma_f32_32x32x16_bf16 v[96:111], a[196:199], v[48:51], v[96:111]
    ds_read_b128 a[212:215], v20 offset:0
    ds_read_b64_tr_b16 v[68:69], v22 offset:10240
    ds_read_b64_tr_b16 v[70:71], v22 offset:10752
    buffer_load_dwordx4 v12, s[16:19], s54 offen offset:1024  lds
    s_add_u32 s61, s61, 1
    s_cmp_eq_u32 s61, 7
    s_cselect_b32 s61, 0, s61
    v_mfma_f32_32x32x16_bf16 v[112:127], v[52:55], a[192:195], v[112:127]
    v_mfma_f32_32x32x16_bf16 v[128:143], v[52:55], a[196:199], v[128:143]
    s_waitcnt lgkmcnt(6)
    v_mfma_f32_32x32x16_bf16 v[80:95], a[200:203], v[56:59], v[80:95]
    ds_read_b64_tr_b16 v[72:73], v22 offset:12288
    ds_read_b64_tr_b16 v[74:75], v22 offset:12800
    ds_read_b128 a[216:219], v17 offset:0
    v_mfma_f32_32x32x16_bf16 v[96:111], a[204:207], v[56:59], v[96:111]
    ds_read_b128 a[220:223], v21 offset:0
    ds_read_b64_tr_b16 v[76:77], v22 offset:14336
    ds_read_b64_tr_b16 v[78:79], v22 offset:14848
    v_mfma_f32_32x32x16_bf16 v[112:127], v[60:63], a[200:203], v[112:127]
    v_mfma_f32_32x32x16_bf16 v[128:143], v[60:63], a[204:207], v[128:143]
    s_waitcnt lgkmcnt(6)
    v_mfma_f32_32x32x16_bf16 v[80:95], a[208:211], v[64:67], v[80:95]
    v_mfma_f32_32x32x16_bf16 v[96:111], a[212:215], v[64:67], v[96:111]
    v_mfma_f32_32x32x16_bf16 v[112:127], v[68:71], a[208:211], v[112:127]
    v_mfma_f32_32x32x16_bf16 v[128:143], v[68:71], a[212:215], v[128:143]
    s_waitcnt lgkmcnt(0)
    v_mfma_f32_32x32x16_bf16 v[80:95], a[216:219], v[72:75], v[80:95]
    v_mfma_f32_32x32x16_bf16 v[96:111], a[220:223], v[72:75], v[96:111]
    v_mfma_f32_32x32x16_bf16 v[112:127], v[76:79], a[216:219], v[112:127]
    v_mfma_f32_32x32x16_bf16 v[128:143], v[76:79], a[220:223], v[128:143]
L_p1done:
    s_nop 8
    v_cvt_pk_bf16_f32 v80, v80, v81
    v_cvt_pk_bf16_f32 v81, v82, v83
    v_cvt_pk_bf16_f32 v82, v84, v85
    v_cvt_pk_bf16_f32 v83, v86, v87
    buffer_store_dwordx4 v[80:83], v24, s[20:23], s56 offen offset:0 sc1
    v_cvt_pk_bf16_f32 v84, v88, v89
    v_cvt_pk_bf16_f32 v85, v90, v91
    v_cvt_pk_bf16_f32 v86, v92, v93
    v_cvt_pk_bf16_f32 v87, v94, v95
    buffer_store_dwordx4 v[84:87], v24, s[20:23], s56 offen offset:1024 sc1
    v_cvt_pk_bf16_f32 v96, v96, v97
    v_cvt_pk_bf16_f32 v97, v98, v99
    v_cvt_pk_bf16_f32 v98, v100, v101
    v_cvt_pk_bf16_f32 v99, v102, v103
    buffer_store_dwordx4 v[96:99], v24, s[20:23], s57 offen offset:0 sc1
    v_cvt_pk_bf16_f32 v100, v104, v105
    v_cvt_pk_bf16_f32 v101, v106, v107
    v_cvt_pk_bf16_f32 v102, v108, v109
    v_cvt_pk_bf16_f32 v103, v110, v111
    buffer_store_dwordx4 v[100:103], v24, s[20:23], s57 offen offset:1024 sc1
    v_add_u32 v22, 0x4000, v22
    s_waitcnt vmcnt(6)
    ds_write_b16 v25, v27
    ds_write_b16 v26, v28
    s_mov_b32 s55, 0x1d0000
    s_waitcnt lgkmcnt(0)
    s_barrier
    ds_read_b64_tr_b16 v[64:65], v23 offset:0
    ds_read_b64_tr_b16 v[66:67], v23 offset:256
    ds_read_b64_tr_b16 v[68:69], v23 offset:1024
    ds_read_b64_tr_b16 v[70:71], v23 offset:1280
    ds_read_b64_tr_b16 v[72:73], v23 offset:2048
    ds_read_b64_tr_b16 v[74:75], v23 offset:2304
    v_mul_f32 v240, s72, v112
    v_mul_f32 v241, s72, v113
    v_mul_f32 v242, s72, v114
    v_mul_f32 v243, s72, v115
    v_exp_f32 v240, v240
    v_exp_f32 v241, v241
    v_exp_f32 v242, v242
    v_exp_f32 v243, v243
    v_fma_f32 v244, v240, 0.5, 1.0
    v_fma_f32 v245, v241, 0.5, 1.0
    v_fma_f32 v246, v242, 0.5, 1.0
    v_fma_f32 v247, v243, 0.5, 1.0
    s_waitcnt lgkmcnt(4)
    v_mfma_f32_32x32x16_bf16 v[208:223], v[64:67], a[0:3], 0
    s_waitcnt lgkmcnt(2)
    ds_read_b64_tr_b16 v[76:77], v23 offset:3072
    ds_read_b64_tr_b16 v[78:79], v23 offset:3328
    v_fma_f32 v244, v240, v244, 1.0
    v_fma_f32 v245, v241, v245, 1.0
    v_fma_f32 v246, v242, v246, 1.0
    v_fma_f32 v247, v243, v247, 1.0
    v_mfma_f32_32x32x16_bf16 v[208:223], v[68:71], a[8:11], v[208:223]
    s_waitcnt lgkmcnt(2)
    ds_read_b64_tr_b16 v[64:65], v23 offset:4096
    ds_read_b64_tr_b16 v[66:67], v23 offset:4352
    s_lshr_b32 s52, s51, 1
    s_add_u32 m0, s52, 65536
    s_mul_i32 s54, s61, 229376
    s_add_u32 s54, s54, s50
    s_add_u32 s54, s54, 128
    buffer_load_dwordx4 v11, s[16:19], s54 offen offset:0  lds
    v_rcp_f32 v244, v244
    v_rcp_f32 v245, v245
    v_mfma_f32_32x32x16_bf16 v[208:223], v[72:75], a[16:19], v[208:223]
    s_waitcnt lgkmcnt(2)
    ds_read_b64_tr_b16 v[68:69], v23 offset:5120
    ds_read_b64_tr_b16 v[70:71], v23 offset:5376
    v_rcp_f32 v246, v246
    v_rcp_f32 v247, v247
    v_fma_f32 v240, -v112, v244, v112
    v_mfma_f32_32x32x16_bf16 v[208:223], v[76:79], a[24:27], v[208:223]
    s_waitcnt lgkmcnt(2)
    ds_read_b64_tr_b16 v[72:73], v23 offset:6144
    ds_read_b64_tr_b16 v[74:75], v23 offset:6400
    buffer_load_dwordx4 v12, s[16:19], s54 offen offset:1024  lds
    s_add_u32 s61, s61, 1
    s_cmp_eq_u32 s61, 7
    s_cselect_b32 s61, 0, s61
    v_fma_f32 v241, -v113, v245, v113
    v_fma_f32 v242, -v114, v246, v114
    v_fma_f32 v243, -v115, v247, v115
    v_cvt_pk_bf16_f32 v112, v240, v241
    v_cvt_pk_bf16_f32 v113, v242, v243
    v_mfma_f32_32x32x16_bf16 v[208:223], v[64:67], a[32:35], v[208:223]
    s_waitcnt lgkmcnt(2)
    ds_read_b64_tr_b16 v[76:77], v23 offset:7168
    ds_read_b64_tr_b16 v[78:79], v23 offset:7424
    v_mul_f32 v248, s72, v116
    v_mul_f32 v249, s72, v117
    v_mul_f32 v250, s72, v118
    v_mul_f32 v251, s72, v119
    v_mfma_f32_32x32x16_bf16 v[208:223], v[68:71], a[40:43], v[208:223]
    s_waitcnt lgkmcnt(2)
    ds_read_b64_tr_b16 v[64:65], v23 offset:8192
    ds_read_b64_tr_b16 v[66:67], v23 offset:8448
    s_lshr_b32 s52, s51, 1
    s_add_u32 m0, s52, 73728
    s_mul_i32 s54, s61, 229376
    s_add_u32 s54, s54, s50
    s_add_u32 s54, s54, 128
    buffer_load_dwordx4 v11, s[16:19], s54 offen offset:0  lds
    v_exp_f32 v248, v248
    v_exp_f32 v249, v249
    v_mfma_f32_32x32x16_bf16 v[208:223], v[72:75], a[48:51], v[208:223]
    s_waitcnt lgkmcnt(2)
    ds_read_b64_tr_b16 v[68:69], v23 offset:9216
    ds_read_b64_tr_b16 v[70:71], v23 offset:9472
    v_exp_f32 v250, v250
    v_exp_f32 v251, v251
    v_fma_f32 v252, v248, 0.5, 1.0
    v_mfma_f32_32x32x16_bf16 v[208:223], v[76:79], a[56:59], v[208:223]
    s_waitcnt lgkmcnt(2)
    ds_read_b64_tr_b16 v[72:73], v23 offset:10240
    ds_read_b64_tr_b16 v[74:75], v23 offset:10496
    buffer_load_dwordx4 v12, s[16:19], s54 offen offset:1024  lds
    s_add_u32 s61, s61, 1
    s_cmp_eq_u32 s61, 7
    s_cselect_b32 s61, 0, s61
    v_fma_f32 v253, v249, 0.5, 1.0
    v_fma_f32 v254, v250, 0.5, 1.0
    v_fma_f32 v255, v251, 0.5, 1.0
    v_fma_f32 v252, v248, v252, 1.0
    v_fma_f32 v253, v249, v253, 1.0
    v_mfma_f32_32x32x16_bf16 v[208:223], v[64:67], a[64:67], v[208:223]
    s_waitcnt lgkmcnt(2)
    ds_read_b64_tr_b16 v[76:77], v23 offset:11264
    ds_read_b64_tr_b16 v[78:79], v23 offset:11520
    v_fma_f32 v254, v250, v254, 1.0
    v_fma_f32 v255, v251, v255, 1.0
    v_rcp_f32 v252, v252
    v_mfma_f32_32x32x16_bf16 v[208:223], v[68:71], a[72:75], v[208:223]
    s_waitcnt lgkmcnt(2)
    ds_read_b64_tr_b16 v[64:65], v23 offset:12288
    ds_read_b64_tr_b16 v[66:67], v23 offset:12544
    s_lshr_b32 s52, s51, 1
    s_add_u32 m0, s52, 81920
    s_mul_i32 s54, s61, 229376
    s_add_u32 s54, s54, s50
    s_add_u32 s54, s54, 128
    buffer_load_dwordx4 v11, s[16:19], s54 offen offset:0  lds
    v_rcp_f32 v253, v253
    v_rcp_f32 v254, v254
    v_mfma_f32_32x32x16_bf16 v[208:223], v[72:75], a[80:83], v[208:223]
    s_waitcnt lgkmcnt(2)
    ds_read_b64_tr_b16 v[68:69], v23 offset:13312
    ds_read_b64_tr_b16 v[70:71], v23 offset:13568
    v_rcp_f32 v255, v255
    v_fma_f32 v248, -v116, v252, v116
    v_fma_f32 v249, -v117, v253, v117
    v_fma_f32 v250, -v118, v254, v118
    v_mfma_f32_32x32x16_bf16 v[208:223], v[76:79], a[88:91], v[208:223]
    s_waitcnt lgkmcnt(2)
    ds_read_b64_tr_b16 v[72:73], v23 offset:14336
    ds_read_b64_tr_b16 v[74:75], v23 offset:14592
    buffer_load_dwordx4 v12, s[16:19], s54 offen offset:1024  lds
    s_add_u32 s61, s61, 1
    s_cmp_eq_u32 s61, 7
    s_cselect_b32 s61, 0, s61
    v_fma_f32 v251, -v119, v255, v119
    v_cvt_pk_bf16_f32 v114, v248, v249
    v_cvt_pk_bf16_f32 v115, v250, v251
    v_mul_f32 v240, s72, v120
    v_mul_f32 v241, s72, v121
    v_mfma_f32_32x32x16_bf16 v[208:223], v[64:67], a[96:99], v[208:223]
    s_waitcnt lgkmcnt(2)
    ds_read_b64_tr_b16 v[76:77], v23 offset:15360
    ds_read_b64_tr_b16 v[78:79], v23 offset:15616
    v_mul_f32 v242, s72, v122
    v_mul_f32 v243, s72, v123
    v_exp_f32 v240, v240
    v_mfma_f32_32x32x16_bf16 v[208:223], v[68:71], a[104:107], v[208:223]
    s_waitcnt lgkmcnt(2)
    ds_read_b64_tr_b16 v[64:65], v23 offset:16384
    ds_read_b64_tr_b16 v[66:67], v23 offset:16640
    s_lshr_b32 s52, s51, 1
    s_add_u32 m0, s52, 90112
    s_mul_i32 s54, s61, 229376
    s_add_u32 s54, s54, s50
    s_add_u32 s54, s54, 128
    buffer_load_dwordx4 v11, s[16:19], s54 offen offset:0  lds
    v_exp_f32 v241, v241
    v_exp_f32 v242, v242
    v_mfma_f32_32x32x16_bf16 v[208:223], v[72:75], a[112:115], v[208:223]
    s_waitcnt lgkmcnt(2)
    ds_read_b64_tr_b16 v[68:69], v23 offset:17408
    ds_read_b64_tr_b16 v[70:71], v23 offset:17664
    v_exp_f32 v243, v243
    v_fma_f32 v244, v240, 0.5, 1.0
    v_fma_f32 v245, v241, 0.5, 1.0
    v_fma_f32 v246, v242, 0.5, 1.0
    v_mfma_f32_32x32x16_bf16 v[208:223], v[76:79], a[120:123], v[208:223]
    s_waitcnt lgkmcnt(2)
    ds_read_b64_tr_b16 v[72:73], v23 offset:18432
    ds_read_b64_tr_b16 v[74:75], v23 offset:18688
    buffer_load_dwordx4 v12, s[16:19], s54 offen offset:1024  lds
    s_add_u32 s61, s61, 1
    s_cmp_eq_u32 s61, 7
    s_cselect_b32 s61, 0, s61
    v_fma_f32 v247, v243, 0.5, 1.0
    v_fma_f32 v244, v240, v244, 1.0
    v_fma_f32 v245, v241, v245, 1.0
    v_fma_f32 v246, v242, v246, 1.0
    v_mfma_f32_32x32x16_bf16 v[208:223], v[64:67], a[128:131], v[208:223]
    s_waitcnt lgkmcnt(2)
    ds_read_b64_tr_b16 v[76:77], v23 offset:19456
    ds_read_b64_tr_b16 v[78:79], v23 offset:19712
    v_fma_f32 v247, v243, v247, 1.0
    v_rcp_f32 v244, v244
    v_rcp_f32 v245, v245
    v_mfma_f32_32x32x16_bf16 v[208:223], v[68:71], a[136:139], v[208:223]
    s_waitcnt lgkmcnt(2)
    ds_read_b64_tr_b16 v[64:65], v23 offset:20480
    ds_read_b64_tr_b16 v[66:67], v23 offset:20736
    v_rcp_f32 v246, v246
    v_rcp_f32 v247, v247
    v_mfma_f32_32x32x16_bf16 v[208:223], v[72:75], a[144:147], v[208:223]
    s_waitcnt lgkmcnt(2)
    ds_read_b64_tr_b16 v[68:69], v23 offset:21504
    ds_read_b64_tr_b16 v[70:71], v23 offset:21760
    v_fma_f32 v240, -v120, v244, v120
    v_fma_f32 v241, -v121, v245, v121
    v_fma_f32 v242, -v122, v246, v122
    v_fma_f32 v243, -v123, v247, v123
    v_cvt_pk_bf16_f32 v116, v240, v241
    v_mfma_f32_32x32x16_bf16 v[208:223], v[76:79], a[152:155], v[208:223]
    s_waitcnt lgkmcnt(2)
    ds_read_b64_tr_b16 v[72:73], v23 offset:22528
    ds_read_b64_tr_b16 v[74:75], v23 offset:22784
    v_cvt_pk_bf16_f32 v117, v242, v243
    v_mul_f32 v248, s72, v124
    v_mul_f32 v249, s72, v125
    v_mul_f32 v250, s72, v126
    v_mfma_f32_32x32x16_bf16 v[208:223], v[64:67], a[160:163], v[208:223]
    s_waitcnt lgkmcnt(2)
    ds_read_b64_tr_b16 v[76:77], v23 offset:23552
    ds_read_b64_tr_b16 v[78:79], v23 offset:23808
    s_waitcnt vmcnt(8)
    s_barrier
    buffer_store_dword v3, v4, s[20:23], s55 offen sc1
    v_mul_f32 v251, s72, v127
    v_exp_f32 v248, v248
    v_exp_f32 v249, v249
    v_mfma_f32_32x32x16_bf16 v[208:223], v[68:71], a[168:171], v[208:223]
    s_waitcnt lgkmcnt(2)
    ds_read_b64_tr_b16 v[64:65], v23 offset:24576
    ds_read_b64_tr_b16 v[66:67], v23 offset:24832
    s_add_u32 m0, s71, 0
    s_lshl2_add_u32 s54, s2, s5
    v_lshlrev_b32 v47, 7, v1
    v_exp_f32 v250, v250
    v_exp_f32 v251, v251
    v_mfma_f32_32x32x16_bf16 v[208:223], v[72:75], a[176:179], v[208:223]
    s_waitcnt lgkmcnt(2)
    ds_read_b64_tr_b16 v[68:69], v23 offset:25600
    ds_read_b64_tr_b16 v[70:71], v23 offset:25856
    buffer_load_dwordx4 v176, s[28:31], s70 offen offset:0  lds
    s_lshl_b32 s54, s54, 9
    v_min_u32 v47, 384, v47
    v_fma_f32 v252, v248, 0.5, 1.0
    v_fma_f32 v253, v249, 0.5, 1.0
    v_fma_f32 v254, v250, 0.5, 1.0
    v_fma_f32 v255, v251, 0.5, 1.0
    v_fma_f32 v252, v248, v252, 1.0
    v_mfma_f32_32x32x16_bf16 v[208:223], v[76:79], a[184:187], v[208:223]
    s_waitcnt lgkmcnt(2)
    ds_read_b64_tr_b16 v[72:73], v23 offset:26624
    ds_read_b64_tr_b16 v[74:75], v23 offset:26880
    buffer_load_dword v9, v47, s[32:35], s54 offen
    v_fma_f32 v253, v249, v253, 1.0
    v_fma_f32 v254, v250, v254, 1.0
    v_fma_f32 v255, v251, v255, 1.0
    v_rcp_f32 v252, v252
    v_mfma_f32_32x32x16_bf16 v[208:223], v[64:67], a[192:195], v[208:223]
    s_waitcnt lgkmcnt(2)
    ds_read_b64_tr_b16 v[76:77], v23 offset:27648
    ds_read_b64_tr_b16 v[78:79], v23 offset:27904
    s_barrier
    buffer_load_dwordx4 v177, s[28:31], s70 offen offset:1024  lds
    v_rcp_f32 v253, v253
    v_rcp_f32 v254, v254
    v_mfma_f32_32x32x16_bf16 v[208:223], v[68:71], a[200:203], v[208:223]
    s_waitcnt lgkmcnt(2)
    ds_read_b64_tr_b16 v[48:49], v22 offset:32768
    ds_read_b64_tr_b16 v[50:51], v22 offset:33280
    v_rcp_f32 v255, v255
    v_fma_f32 v248, -v124, v252, v124
    v_fma_f32 v249, -v125, v253, v125
    v_mfma_f32_32x32x16_bf16 v[208:223], v[72:75], a[208:211], v[208:223]
    s_waitcnt lgkmcnt(2)
    ds_read_b64_tr_b16 v[52:53], v22 offset:34816
    ds_read_b64_tr_b16 v[54:55], v22 offset:35328
    buffer_load_dwordx4 v178, s[28:31], s70 offen offset:2048  lds
    v_fma_f32 v250, -v126, v254, v126
    v_fma_f32 v251, -v127, v255, v127
    v_cvt_pk_bf16_f32 v118, v248, v249
    v_cvt_pk_bf16_f32 v119, v250, v251
    v_mul_f32 v240, s72, v128
    v_mfma_f32_32x32x16_bf16 v[208:223], v[76:79], a[216:219], v[208:223]
    s_waitcnt lgkmcnt(2)
    ds_read_b64_tr_b16 v[56:57], v22 offset:36864
    ds_read_b64_tr_b16 v[58:59], v22 offset:37376
    v_mul_f32 v241, s72, v129
    v_mul_f32 v242, s72, v130
    v_mul_f32 v243, s72, v131
    v_exp_f32 v240, v240
    v_mfma_f32_32x32x16_bf16 v[144:159], v[48:51], a[0:3], v[192:207]
    v_exp_f32 v241, v241
    v_exp_f32 v242, v242
    v_mfma_f32_32x32x16_bf16 v[160:175], v[48:51], a[4:7], v[192:207]
    s_waitcnt lgkmcnt(2)
    ds_read_b64_tr_b16 v[60:61], v22 offset:38912
    ds_read_b64_tr_b16 v[62:63], v22 offset:39424
    buffer_load_dwordx4 v179, s[28:31], s70 offen offset:3072  lds
    s_add_u32 s70, s70, 28672
    v_exp_f32 v243, v243
    v_fma_f32 v244, v240, 0.5, 1.0
    v_fma_f32 v245, v241, 0.5, 1.0
    v_mfma_f32_32x32x16_bf16 v[144:159], v[52:55], a[8:11], v[144:159]
    s_add_u32 m0, s71, 4096
    s_cmp_eq_u32 s62, 0
    s_cselect_b64 vcc, -1, 0
    v_mov_b32 v41, v208
    v_mov_b32 v42, v208
    v_mfma_f32_32x32x16_bf16 v[160:175], v[52:55], a[12:15], v[160:175]
    s_waitcnt lgkmcnt(2)
    ds_read_b64_tr_b16 v[48:49], v22 offset:40960
    ds_read_b64_tr_b16 v[50:51], v22 offset:41472
    buffer_load_dwordx4 v176, s[28:31], s70 offen offset:0  lds
    v_mov_b32 v43, v220
    v_mov_b32 v44, v220
    v_mul_f32 v208, 0x3e8b97f6, v208
    v_mfma_f32_32x32x16_bf16 v[144:159], v[56:59], a[16:19], v[144:159]
    s_and_b32 s44, s4, 1
    v_mul_f32 v209, 0x3e8b97f6, v209
    v_mul_f32 v210, 0x3e8b97f6, v210
    v_mul_f32 v211, 0x3e8b97f6, v211
    v_mul_f32 v212, 0x3e8b97f6, v212
    v_mfma_f32_32x32x16_bf16 v[160:175], v[56:59], a[20:23], v[160:175]
    s_waitcnt lgkmcnt(2)
    ds_read_b64_tr_b16 v[52:53], v22 offset:43008
    ds_read_b64_tr_b16 v[54:55], v22 offset:43520
    v_mul_f32 v213, 0x3e8b97f6, v213
    v_mul_f32 v214, 0x3e8b97f6, v214
    v_mul_f32 v215, 0x3e8b97f6, v215
    v_mul_f32 v216, 0x3e8b97f6, v216
    v_mfma_f32_32x32x16_bf16 v[144:159], v[60:63], a[24:27], v[144:159]
    buffer_load_dwordx4 v177, s[28:31], s70 offen offset:1024  lds
    v_mul_f32 v217, 0x3e8b97f6, v217
    v_mul_f32 v218, 0x3e8b97f6, v218
    v_mul_f32 v219, 0x3e8b97f6, v219
    v_mul_f32 v220, 0x3e8b97f6, v220
    v_mfma_f32_32x32x16_bf16 v[160:175], v[60:63], a[28:31], v[160:175]
    s_waitcnt lgkmcnt(2)
    ds_read_b64_tr_b16 v[56:57], v22 offset:45056
    ds_read_b64_tr_b16 v[58:59], v22 offset:45568
    v_mul_f32 v221, 0x3e8b97f6, v221
    v_mul_f32 v222, 0x3e8b97f6, v222
    v_mul_f32 v223, 0x3e8b97f6, v223
    v_mfma_f32_32x32x16_bf16 v[144:159], v[48:51], a[32:35], v[144:159]
    buffer_load_dwordx4 v178, s[28:31], s70 offen offset:2048  lds
    v_permlane32_swap_b32 v41, v42
    v_permlane32_swap_b32 v43, v44
    v_cvt_pk_bf16_f32 v208, v208, v209
    v_cvt_pk_bf16_f32 v209, v210, v211
    v_mfma_f32_32x32x16_bf16 v[160:175], v[48:51], a[36:39], v[160:175]
    s_waitcnt lgkmcnt(2)
    ds_read_b64_tr_b16 v[60:61], v22 offset:47104
    ds_read_b64_tr_b16 v[62:63], v22 offset:47616
    v_cvt_pk_bf16_f32 v210, v212, v213
    v_cvt_pk_bf16_f32 v211, v214, v215
    v_cvt_pk_bf16_f32 v212, v216, v217
    v_cvt_pk_bf16_f32 v213, v218, v219
    v_mfma_f32_32x32x16_bf16 v[144:159], v[52:55], a[40:43], v[144:159]
    buffer_load_dwordx4 v179, s[28:31], s70 offen offset:3072  lds
    s_add_u32 s70, s70, 28672
    s_cmp_eq_u32 s70, s84
    s_cselect_b32 s70, s79, s70
    v_cvt_pk_bf16_f32 v214, v220, v221
    v_cvt_pk_bf16_f32 v215, v222, v223
    v_cndmask_b32 v41, v41, v44, vcc
    v_mfma_f32_32x32x16_bf16 v[160:175], v[52:55], a[44:47], v[160:175]
    s_waitcnt lgkmcnt(2)
    ds_read_b64_tr_b16 v[48:49], v22 offset:49152
    ds_read_b64_tr_b16 v[50:51], v22 offset:49664
    v_and_b32 v208, v29, v208
    v_and_b32 v209, v29, v209
    v_and_b32 v214, v30, v214
    v_and_b32 v215, v30, v215
    v_mfma_f32_32x32x16_bf16 v[144:159], v[56:59], a[48:51], v[144:159]
    ds_write_b128 v39, v[208:211] offset:0
    ds_write_b128 v39, v[212:215] offset:1024
    s_add_u32 m0, s71, 8192
    v_mul_f32 v41, 0xbfb8aa3b, v41
    v_exp_f32 v41, v41
    v_accvgpr_write_b32 a224, v208
    v_accvgpr_write_b32 a225, v209
    v_mfma_f32_32x32x16_bf16 v[160:175], v[56:59], a[52:55], v[160:175]
    s_waitcnt lgkmcnt(4)
    ds_read_b64_tr_b16 v[52:53], v22 offset:51200
    ds_read_b64_tr_b16 v[54:55], v22 offset:51712
    buffer_load_dwordx4 v176, s[28:31], s70 offen offset:0  lds
    v_accvgpr_write_b32 a226, v210
    v_accvgpr_write_b32 a227, v211
    v_accvgpr_write_b32 a228, v212
    v_accvgpr_write_b32 a229, v213
    v_mfma_f32_32x32x16_bf16 v[144:159], v[60:63], a[56:59], v[144:159]
    s_lshl1_add_u32 s48, s69, s44
    v_accvgpr_write_b32 a230, v214
    v_accvgpr_write_b32 a231, v215
    v_add_f32 v43, 1.0, v41
    v_rcp_f32 v31, v43
    v_mfma_f32_32x32x16_bf16 v[160:175], v[60:63], a[60:63], v[160:175]
    s_waitcnt lgkmcnt(4)
    ds_read_b64_tr_b16 v[56:57], v22 offset:53248
    ds_read_b64_tr_b16 v[58:59], v22 offset:53760
    buffer_load_dwordx4 v177, s[28:31], s70 offen offset:1024  lds
    v_xor_b32 v44, 2048, v39
    v_xor_b32 v45, 4096, v39
    v_xor_b32 v46, 6144, v39
    v_sub_f32 v43, 1.0, v31
    v_mfma_f32_32x32x16_bf16 v[144:159], v[48:51], a[64:67], v[144:159]
    s_waitcnt vmcnt(12) lgkmcnt(4)
    s_barrier
    v_fma_f32 v246, v242, 0.5, 1.0
    v_fma_f32 v247, v243, 0.5, 1.0
    v_fma_f32 v244, v240, v244, 1.0
    v_fma_f32 v245, v241, v245, 1.0
    v_fma_f32 v246, v242, v246, 1.0
    v_fma_f32 v247, v243, v247, 1.0
    v_mfma_f32_32x32x16_bf16 v[160:175], v[48:51], a[68:71], v[160:175]
    s_waitcnt lgkmcnt(2)
    ds_read_b64_tr_b16 v[60:61], v22 offset:55296
    ds_read_b64_tr_b16 v[62:63], v22 offset:55808
    v_rcp_f32 v244, v244
    v_rcp_f32 v245, v245
    v_rcp_f32 v246, v246
    v_mfma_f32_32x32x16_bf16 v[144:159], v[52:55], a[72:75], v[144:159]
    ds_read_b128 a[232:235], v44 offset:0
    ds_read_b128 a[236:239], v44 offset:1024
    buffer_load_dwordx4 v178, s[28:31], s70 offen offset:2048  lds
    v_rcp_f32 v247, v247
    v_fma_f32 v240, -v128, v244, v128
    v_fma_f32 v241, -v129, v245, v129
    v_fma_f32 v242, -v130, v246, v130
    v_mfma_f32_32x32x16_bf16 v[160:175], v[52:55], a[76:79], v[160:175]
    s_waitcnt lgkmcnt(4)
    ds_read_b64_tr_b16 v[64:65], v22 offset:0
    ds_read_b64_tr_b16 v[66:67], v22 offset:512
    v_fma_f32 v243, -v131, v247, v131
    v_cvt_pk_bf16_f32 v128, v240, v241
    v_cvt_pk_bf16_f32 v129, v242, v243
    v_mul_f32 v248, s72, v132
    v_mul_f32 v249, s72, v133
    v_mfma_f32_32x32x16_bf16 v[144:159], v[56:59], a[80:83], v[144:159]
    ds_read_b128 a[240:243], v45 offset:0
    ds_read_b128 a[244:247], v45 offset:1024
    buffer_load_dwordx4 v179, s[28:31], s70 offen offset:3072  lds
    s_add_u32 s70, s70, 28672
    v_mul_f32 v250, s72, v134
    v_mul_f32 v251, s72, v135
    v_exp_f32 v248, v248
    v_exp_f32 v249, v249
    v_mfma_f32_32x32x16_bf16 v[160:175], v[56:59], a[84:87], v[160:175]
    s_waitcnt lgkmcnt(6)
    ds_read_b64_tr_b16 v[68:69], v22 offset:2048
    ds_read_b64_tr_b16 v[70:71], v22 offset:2560
    s_add_u32 m0, s71, 12288
    v_exp_f32 v250, v250
    v_exp_f32 v251, v251
    v_fma_f32 v252, v248, 0.5, 1.0
    v_mfma_f32_32x32x16_bf16 v[144:159], v[60:63], a[88:91], v[144:159]
    ds_read_b128 a[248:251], v46 offset:0
    ds_read_b128 a[252:255], v46 offset:1024
    buffer_load_dwordx4 v176, s[28:31], s70 offen offset:0  lds
    v_fma_f32 v253, v249, 0.5, 1.0
    v_fma_f32 v254, v250, 0.5, 1.0
    v_fma_f32 v255, v251, 0.5, 1.0
    v_fma_f32 v252, v248, v252, 1.0
    v_fma_f32 v253, v249, v253, 1.0
    v_fma_f32 v254, v250, v254, 1.0
    v_mfma_f32_32x32x16_bf16 v[160:175], v[60:63], a[92:95], v[160:175]
    s_waitcnt lgkmcnt(6)
    ds_read_b64_tr_b16 v[72:73], v22 offset:4096
    ds_read_b64_tr_b16 v[74:75], v22 offset:4608
    v_fma_f32 v255, v251, v255, 1.0
    v_rcp_f32 v252, v252
    v_rcp_f32 v253, v253
    v_mfma_f32_32x32x16_bf16 v[144:159], v[64:67], a[96:99], v[144:159]
    s_waitcnt lgkmcnt(4)
    ds_read_b64_tr_b16 v[76:77], v22 offset:6144
    ds_read_b64_tr_b16 v[78:79], v22 offset:6656
    v_rcp_f32 v254, v254
    v_rcp_f32 v255, v255
    v_fma_f32 v248, -v132, v252, v132
    v_fma_f32 v249, -v133, v253, v133
    v_mfma_f32_32x32x16_bf16 v[144:159], v[68:71], a[104:107], v[144:159]
    s_waitcnt lgkmcnt(2)
    ds_read_b64_tr_b16 v[80:81], v22 offset:8192
    ds_read_b64_tr_b16 v[82:83], v22 offset:8704
    buffer_load_dwordx4 v177, s[28:31], s70 offen offset:1024  lds
    v_fma_f32 v250, -v134, v254, v134
    v_fma_f32 v251, -v135, v255, v135
    v_cvt_pk_bf16_f32 v130, v248, v249
    v_cvt_pk_bf16_f32 v131, v250, v251
    v_mul_f32 v240, s72, v136
    v_mfma_f32_32x32x16_bf16 v[144:159], v[72:75], a[112:115], v[144:159]
    s_waitcnt lgkmcnt(2)
    ds_read_b64_tr_b16 v[84:85], v22 offset:10240
    ds_read_b64_tr_b16 v[86:87], v22 offset:10752
    v_mul_f32 v241, s72, v137
    v_mul_f32 v242, s72, v138
    v_mul_f32 v243, s72, v139
    v_exp_f32 v240, v240
    v_exp_f32 v241, v241
    v_mfma_f32_32x32x16_bf16 v[144:159], v[76:79], a[120:123], v[144:159]
    s_waitcnt lgkmcnt(2)
    ds_read_b64_tr_b16 v[88:89], v22 offset:12288
    ds_read_b64_tr_b16 v[90:91], v22 offset:12800
    buffer_load_dwordx4 v178, s[28:31], s70 offen offset:2048  lds
    v_exp_f32 v242, v242
    v_exp_f32 v243, v243
    v_fma_f32 v244, v240, 0.5, 1.0
    v_mfma_f32_32x32x16_bf16 v[144:159], v[80:83], a[128:131], v[144:159]
    s_waitcnt lgkmcnt(2)
    ds_read_b64_tr_b16 v[92:93], v22 offset:14336
    ds_read_b64_tr_b16 v[94:95], v22 offset:14848
    v_fma_f32 v245, v241, 0.5, 1.0
    v_fma_f32 v246, v242, 0.5, 1.0
    v_fma_f32 v247, v243, 0.5, 1.0
    v_fma_f32 v244, v240, v244, 1.0
    v_fma_f32 v245, v241, v245, 1.0
    v_mfma_f32_32x32x16_bf16 v[144:159], v[84:87], a[136:139], v[144:159]
    s_waitcnt lgkmcnt(2)
    ds_read_b64_tr_b16 v[192:193], v22 offset:16384
    ds_read_b64_tr_b16 v[194:195], v22 offset:16896
    v_fma_f32 v246, v242, v246, 1.0
    v_fma_f32 v247, v243, v247, 1.0
    v_rcp_f32 v244, v244
    v_rcp_f32 v245, v245
    v_mfma_f32_32x32x16_bf16 v[144:159], v[88:91], a[144:147], v[144:159]
    s_waitcnt lgkmcnt(2)
    ds_read_b64_tr_b16 v[196:197], v22 offset:18432
    ds_read_b64_tr_b16 v[198:199], v22 offset:18944
    s_lshl_b32 s55, s5, 13
    buffer_load_dwordx4 v179, s[28:31], s70 offen offset:3072  lds
    s_add_u32 s70, s70, 28672
    s_cmp_eq_u32 s70, s84
    s_cselect_b32 s70, s79, s70
    v_rcp_f32 v246, v246
    v_rcp_f32 v247, v247
    v_fma_f32 v240, -v136, v244, v136
    v_mfma_f32_32x32x16_bf16 v[144:159], v[92:95], a[152:155], v[144:159]
    s_waitcnt lgkmcnt(2)
    ds_read_b64_tr_b16 v[200:201], v22 offset:20480
    ds_read_b64_tr_b16 v[202:203], v22 offset:20992
    s_add_u32 s55, s55, 0x1d0000
    v_fma_f32 v241, -v137, v245, v137
    v_fma_f32 v242, -v138, v246, v138
    v_fma_f32 v243, -v139, v247, v139
    v_cvt_pk_bf16_f32 v132, v240, v241
    v_cvt_pk_bf16_f32 v133, v242, v243
    v_mul_f32 v248, s72, v140
    v_mfma_f32_32x32x16_bf16 v[144:159], v[192:195], a[160:163], v[144:159]
    s_waitcnt lgkmcnt(2)
    ds_read_b64_tr_b16 v[204:205], v22 offset:22528
    ds_read_b64_tr_b16 v[206:207], v22 offset:23040
    buffer_load_dword v35, v34, s[20:23], s55 offen sc1
    v_mul_f32 v249, s72, v141
    v_mul_f32 v250, s72, v142
    v_mul_f32 v251, s72, v143
    v_exp_f32 v248, v248
    v_mfma_f32_32x32x16_bf16 v[144:159], v[196:199], a[168:171], v[144:159]
    s_waitcnt lgkmcnt(2)
    ds_read_b64_tr_b16 v[48:49], v22 offset:24576
    ds_read_b64_tr_b16 v[50:51], v22 offset:25088
    v_exp_f32 v249, v249
    v_exp_f32 v250, v250
    v_exp_f32 v251, v251
    v_mfma_f32_32x32x16_bf16 v[144:159], v[200:203], a[176:179], v[144:159]
    s_waitcnt lgkmcnt(2)
    ds_read_b64_tr_b16 v[52:53], v22 offset:26624
    ds_read_b64_tr_b16 v[54:55], v22 offset:27136
    v_fma_f32 v252, v248, 0.5, 1.0
    v_fma_f32 v253, v249, 0.5, 1.0
    v_fma_f32 v254, v250, 0.5, 1.0
    v_fma_f32 v255, v251, 0.5, 1.0
    v_fma_f32 v252, v248, v252, 1.0
    v_mfma_f32_32x32x16_bf16 v[144:159], v[204:207], a[184:187], v[144:159]
    s_waitcnt lgkmcnt(2)
    ds_read_b64_tr_b16 v[56:57], v22 offset:28672
    ds_read_b64_tr_b16 v[58:59], v22 offset:29184
    v_fma_f32 v253, v249, v253, 1.0
    v_fma_f32 v254, v250, v254, 1.0
    v_fma_f32 v255, v251, v255, 1.0
    v_rcp_f32 v252, v252
    v_mfma_f32_32x32x16_bf16 v[144:159], v[48:51], a[192:195], v[144:159]
    s_waitcnt lgkmcnt(2)
    ds_read_b64_tr_b16 v[60:61], v22 offset:30720
    ds_read_b64_tr_b16 v[62:63], v22 offset:31232
    v_rcp_f32 v253, v253
    v_rcp_f32 v254, v254
    v_rcp_f32 v255, v255
    v_mfma_f32_32x32x16_bf16 v[144:159], v[52:55], a[200:203], v[144:159]
    s_waitcnt lgkmcnt(2)
    v_fma_f32 v248, -v140, v252, v140
    v_fma_f32 v249, -v141, v253, v141
    v_fma_f32 v250, -v142, v254, v142
    v_fma_f32 v251, -v143, v255, v143
    v_cvt_pk_bf16_f32 v134, v248, v249
    v_cvt_pk_bf16_f32 v135, v250, v251
    v_mfma_f32_32x32x16_bf16 v[144:159], v[56:59], a[208:211], v[144:159]
    s_waitcnt lgkmcnt(0)
    v_mfma_f32_32x32x16_bf16 v[144:159], v[60:63], a[216:219], v[144:159]
    s_lshr_b32 s44, s4, 1
    v_mfma_f32_32x32x16_bf16 v[160:175], v[64:67], a[100:103], v[160:175]
    s_lshl3_add_u32 s48, s48, s44
    v_mfma_f32_32x32x16_bf16 v[160:175], v[68:71], a[108:111], v[160:175]
    s_lshl_b32 s48, s48, 7
    s_nop 6
    v_mul_f32 v240, s72, v144
    v_mul_f32 v241, s72, v145
    v_mul_f32 v242, s72, v146
    v_mul_f32 v243, s72, v147
    v_exp_f32 v240, v240
    v_mfma_f32_32x32x16_bf16 v[160:175], v[72:75], a[116:119], v[160:175]
    s_add_u32 s48, s48, 0x1e0000
    v_exp_f32 v241, v241
    v_exp_f32 v242, v242
    v_exp_f32 v243, v243
    v_fma_f32 v244, v240, 0.5, 1.0
    v_fma_f32 v245, v241, 0.5, 1.0
    v_mfma_f32_32x32x16_bf16 v[160:175], v[76:79], a[124:127], v[160:175]
    s_lshr_b32 s49, s85, 1
    v_fma_f32 v246, v242, 0.5, 1.0
    v_fma_f32 v247, v243, 0.5, 1.0
    v_fma_f32 v244, v240, v244, 1.0
    v_fma_f32 v245, v241, v245, 1.0
    v_fma_f32 v246, v242, v246, 1.0
    v_fma_f32 v247, v243, v247, 1.0
    v_mfma_f32_32x32x16_bf16 v[160:175], v[80:83], a[132:135], v[160:175]
    s_lshl2_add_u32 s49, s49, s5
    v_rcp_f32 v244, v244
    v_rcp_f32 v245, v245
    v_rcp_f32 v246, v246
    v_rcp_f32 v247, v247
    v_mfma_f32_32x32x16_bf16 v[160:175], v[84:87], a[140:143], v[160:175]
    s_lshl_b32 s49, s49, 10
    v_fma_f32 v240, -v144, v244, v144
    v_fma_f32 v241, -v145, v245, v145
    v_fma_f32 v242, -v146, v246, v146
    v_fma_f32 v243, -v147, v247, v147
    v_cvt_pk_bf16_f32 v96, v240, v241
    v_cvt_pk_bf16_f32 v97, v242, v243
    v_mfma_f32_32x32x16_bf16 v[160:175], v[88:91], a[148:151], v[160:175]
    s_add_u32 s49, s49, 0x1e0000
    v_mul_f32 v248, s72, v148
    v_mul_f32 v249, s72, v149
    v_mul_f32 v250, s72, v150
    v_mul_f32 v251, s72, v151
    v_exp_f32 v248, v248
    v_mfma_f32_32x32x16_bf16 v[160:175], v[92:95], a[156:159], v[160:175]
    s_lshl4_add_u32 s44, s85, s5
    v_exp_f32 v249, v249
    v_exp_f32 v250, v250
    v_exp_f32 v251, v251
    v_fma_f32 v252, v248, 0.5, 1.0
    v_fma_f32 v253, v249, 0.5, 1.0
    v_mfma_f32_32x32x16_bf16 v[160:175], v[192:195], a[164:167], v[160:175]
    s_lshl_b32 s44, s44, 11
    v_fma_f32 v254, v250, 0.5, 1.0
    v_fma_f32 v255, v251, 0.5, 1.0
    v_fma_f32 v252, v248, v252, 1.0
    v_fma_f32 v253, v249, v253, 1.0
    v_fma_f32 v254, v250, v254, 1.0
    v_fma_f32 v255, v251, v255, 1.0
    v_mfma_f32_32x32x16_bf16 v[160:175], v[196:199], a[172:175], v[160:175]
    v_add_u32 v5, s44, v2
    v_rcp_f32 v252, v252
    v_rcp_f32 v253, v253
    v_rcp_f32 v254, v254
    v_rcp_f32 v255, v255
    v_mfma_f32_32x32x16_bf16 v[160:175], v[200:203], a[180:183], v[160:175]
    v_xor_b32 v6, 0x1000, v5
    v_fma_f32 v248, -v148, v252, v148
    v_fma_f32 v249, -v149, v253, v149
    v_fma_f32 v250, -v150, v254, v150
    v_fma_f32 v251, -v151, v255, v151
    v_cvt_pk_bf16_f32 v98, v248, v249
    v_cvt_pk_bf16_f32 v99, v250, v251
    v_mfma_f32_32x32x16_bf16 v[160:175], v[204:207], a[188:191], v[160:175]
    v_xor_b32 v7, 24576, v190
    v_mul_f32 v240, s72, v152
    v_mul_f32 v241, s72, v153
    v_mul_f32 v242, s72, v154
    v_mul_f32 v243, s72, v155
    v_exp_f32 v240, v240
    v_mfma_f32_32x32x16_bf16 v[160:175], v[48:51], a[196:199], v[160:175]
    v_exp_f32 v241, v241
    v_exp_f32 v242, v242
    v_exp_f32 v243, v243
    v_fma_f32 v244, v240, 0.5, 1.0
    v_fma_f32 v245, v241, 0.5, 1.0
    v_mfma_f32_32x32x16_bf16 v[160:175], v[52:55], a[204:207], v[160:175]
    v_fma_f32 v246, v242, 0.5, 1.0
    v_fma_f32 v247, v243, 0.5, 1.0
    v_fma_f32 v244, v240, v244, 1.0
    v_fma_f32 v245, v241, v245, 1.0
    v_fma_f32 v246, v242, v246, 1.0
    v_fma_f32 v247, v243, v247, 1.0
    v_mfma_f32_32x32x16_bf16 v[160:175], v[56:59], a[212:215], v[160:175]
    v_rcp_f32 v244, v244
    v_rcp_f32 v245, v245
    v_rcp_f32 v246, v246
    v_rcp_f32 v247, v247
    v_mfma_f32_32x32x16_bf16 v[160:175], v[60:63], a[220:223], v[160:175]
    v_fma_f32 v240, -v152, v244, v152
    v_fma_f32 v241, -v153, v245, v153
    v_fma_f32 v242, -v154, v246, v154
    v_fma_f32 v243, -v155, v247, v155
    v_cvt_pk_bf16_f32 v100, v240, v241
    v_cvt_pk_bf16_f32 v101, v242, v243
    s_waitcnt vmcnt(0)
    v_cmp_ne_u32 vcc, v35, v3
    s_nop 0
    s_and_b64 vcc, vcc, s[64:65]
    s_cselect_b32 s90, 0x40000000, 0
    s_add_u32 s66, s66, s90
    s_add_u32 s67, s67, s90
    v_pk_mul_f32 v[248:249], v[156:157], s[72:73] op_sel_hi:[1,0]
    v_pk_mul_f32 v[250:251], v[158:159], s[72:73] op_sel_hi:[1,0]
    v_exp_f32 v248, v248
    v_exp_f32 v249, v249
    v_exp_f32 v250, v250
    v_exp_f32 v251, v251
    v_pk_fma_f32 v[252:253], v[248:249], 0.5, 1.0 op_sel_hi:[1,0,0]
    v_pk_fma_f32 v[254:255], v[250:251], 0.5, 1.0 op_sel_hi:[1,0,0]
    buffer_load_dwordx4 a[0:3], v2, s[20:23], s66 offen offset:0 sc1
    v_pk_fma_f32 v[252:253], v[248:249], v[252:253], 1.0 op_sel_hi:[1,1,0]
    v_pk_fma_f32 v[254:255], v[250:251], v[254:255], 1.0 op_sel_hi:[1,1,0]
    v_rcp_f32 v252, v252
    v_rcp_f32 v253, v253
    v_rcp_f32 v254, v254
    v_rcp_f32 v255, v255
    v_pk_fma_f32 v[248:249], v[156:157], v[252:253], v[156:157] neg_lo:[1,0,0] neg_hi:[1,0,0]
    v_pk_fma_f32 v[250:251], v[158:159], v[254:255], v[158:159] neg_lo:[1,0,0] neg_hi:[1,0,0]
    buffer_load_dwordx4 a[4:7], v2, s[20:23], s66 offen offset:1024 sc1
    s_add_u32 s66, s66, 28672
    v_cvt_pk_bf16_f32 v102, v248, v249
    v_cvt_pk_bf16_f32 v103, v250, v251
    v_mov_b32 v14, -1
    v_mov_b32 v15, -1
    v_mov_b32 v16, -1
    v_mov_b32 v17, -1
    v_pk_mul_f32 v[240:241], v[160:161], s[72:73] op_sel_hi:[1,0]
    v_pk_mul_f32 v[242:243], v[162:163], s[72:73] op_sel_hi:[1,0]
    buffer_load_dwordx4 a[8:11], v36, s[20:23], s67 offen offset:0 sc1
    v_exp_f32 v240, v240
    v_exp_f32 v241, v241
    v_exp_f32 v242, v242
    v_exp_f32 v243, v243
    v_pk_fma_f32 v[244:245], v[240:241], 0.5, 1.0 op_sel_hi:[1,0,0]
    v_pk_fma_f32 v[246:247], v[242:243], 0.5, 1.0 op_sel_hi:[1,0,0]
    v_pk_fma_f32 v[244:245], v[240:241], v[244:245], 1.0 op_sel_hi:[1,1,0]
    v_pk_fma_f32 v[246:247], v[242:243], v[246:247], 1.0 op_sel_hi:[1,1,0]
    buffer_load_dwordx4 a[12:15], v36, s[20:23], s67 offen offset:1024 sc1
    s_add_u32 s67, s67, 2048
    v_rcp_f32 v244, v244
    v_rcp_f32 v245, v245
    v_rcp_f32 v246, v246
    v_rcp_f32 v247, v247
    v_pk_fma_f32 v[240:241], v[160:161], v[244:245], v[160:161] neg_lo:[1,0,0] neg_hi:[1,0,0]
    v_pk_fma_f32 v[242:243], v[162:163], v[246:247], v[162:163] neg_lo:[1,0,0] neg_hi:[1,0,0]
    v_cvt_pk_bf16_f32 v104, v240, v241
    v_cvt_pk_bf16_f32 v105, v242, v243
    buffer_load_dwordx4 a[16:19], v2, s[20:23], s66 offen offset:0 sc1
    v_pk_mul_f32 v[248:249], v[164:165], s[72:73] op_sel_hi:[1,0]
    v_pk_mul_f32 v[250:251], v[166:167], s[72:73] op_sel_hi:[1,0]
    v_exp_f32 v248, v248
    v_exp_f32 v249, v249
    v_exp_f32 v250, v250
    v_exp_f32 v251, v251
    v_pk_fma_f32 v[252:253], v[248:249], 0.5, 1.0 op_sel_hi:[1,0,0]
    v_pk_fma_f32 v[254:255], v[250:251], 0.5, 1.0 op_sel_hi:[1,0,0]
    buffer_load_dwordx4 a[20:23], v2, s[20:23], s66 offen offset:1024 sc1
    s_add_u32 s66, s66, 28672
    v_pk_fma_f32 v[252:253], v[248:249], v[252:253], 1.0 op_sel_hi:[1,1,0]
    v_pk_fma_f32 v[254:255], v[250:251], v[254:255], 1.0 op_sel_hi:[1,1,0]
    v_rcp_f32 v252, v252
    v_rcp_f32 v253, v253
    v_rcp_f32 v254, v254
    v_rcp_f32 v255, v255
    v_pk_fma_f32 v[248:249], v[164:165], v[252:253], v[164:165] neg_lo:[1,0,0] neg_hi:[1,0,0]
    v_pk_fma_f32 v[250:251], v[166:167], v[254:255], v[166:167] neg_lo:[1,0,0] neg_hi:[1,0,0]
    buffer_load_dwordx4 a[24:27], v36, s[20:23], s67 offen offset:0 sc1
    v_cvt_pk_bf16_f32 v106, v248, v249
    v_cvt_pk_bf16_f32 v107, v250, v251
    v_pk_mul_f32 v[240:241], v[168:169], s[72:73] op_sel_hi:[1,0]
    v_pk_mul_f32 v[242:243], v[170:171], s[72:73] op_sel_hi:[1,0]
    v_exp_f32 v240, v240
    v_exp_f32 v241, v241
    v_exp_f32 v242, v242
    v_exp_f32 v243, v243
    buffer_load_dwordx4 a[28:31], v36, s[20:23], s67 offen offset:1024 sc1
    s_add_u32 s67, s67, 2048
    s_cmp_eq_u32 s67, s76
    s_cselect_b32 s66, s74, s66
    s_cselect_b32 s67, s75, s67
    v_pk_fma_f32 v[244:245], v[240:241], 0.5, 1.0 op_sel_hi:[1,0,0]
    v_pk_fma_f32 v[246:247], v[242:243], 0.5, 1.0 op_sel_hi:[1,0,0]
    v_pk_fma_f32 v[244:245], v[240:241], v[244:245], 1.0 op_sel_hi:[1,1,0]
    v_pk_fma_f32 v[246:247], v[242:243], v[246:247], 1.0 op_sel_hi:[1,1,0]
    v_rcp_f32 v244, v244
    v_rcp_f32 v245, v245
    v_rcp_f32 v246, v246
    v_rcp_f32 v247, v247
    buffer_load_dwordx4 a[32:35], v2, s[20:23], s66 offen offset:0 sc1
    v_pk_fma_f32 v[240:241], v[168:169], v[244:245], v[168:169] neg_lo:[1,0,0] neg_hi:[1,0,0]
    v_pk_fma_f32 v[242:243], v[170:171], v[246:247], v[170:171] neg_lo:[1,0,0] neg_hi:[1,0,0]
    v_cvt_pk_bf16_f32 v108, v240, v241
    v_cvt_pk_bf16_f32 v109, v242, v243
    v_pk_mul_f32 v[248:249], v[172:173], s[72:73] op_sel_hi:[1,0]
    v_pk_mul_f32 v[250:251], v[174:175], s[72:73] op_sel_hi:[1,0]
    v_exp_f32 v248, v248
    v_exp_f32 v249, v249
    buffer_load_dwordx4 a[36:39], v2, s[20:23], s66 offen offset:1024 sc1
    s_add_u32 s66, s66, 28672
    v_exp_f32 v250, v250
    v_exp_f32 v251, v251
    v_pk_fma_f32 v[252:253], v[248:249], 0.5, 1.0 op_sel_hi:[1,0,0]
    v_pk_fma_f32 v[254:255], v[250:251], 0.5, 1.0 op_sel_hi:[1,0,0]
    v_pk_fma_f32 v[252:253], v[248:249], v[252:253], 1.0 op_sel_hi:[1,1,0]
    v_pk_fma_f32 v[254:255], v[250:251], v[254:255], 1.0 op_sel_hi:[1,1,0]
    v_rcp_f32 v252, v252
    v_rcp_f32 v253, v253
    buffer_load_dwordx4 a[40:43], v36, s[20:23], s67 offen offset:0 sc1
    v_rcp_f32 v254, v254
    v_rcp_f32 v255, v255
    v_pk_fma_f32 v[248:249], v[172:173], v[252:253], v[172:173] neg_lo:[1,0,0] neg_hi:[1,0,0]
    v_pk_fma_f32 v[250:251], v[174:175], v[254:255], v[174:175] neg_lo:[1,0,0] neg_hi:[1,0,0]
    v_cvt_pk_bf16_f32 v110, v248, v249
    v_cvt_pk_bf16_f32 v111, v250, v251
    buffer_load_dwordx4 a[44:47], v36, s[20:23], s67 offen offset:1024 sc1
    s_add_u32 s67, s67, 2048
    buffer_load_dwordx4 a[48:51], v2, s[20:23], s66 offen offset:0 sc1
    buffer_load_dwordx4 a[52:55], v2, s[20:23], s66 offen offset:1024 sc1
    s_add_u32 s66, s66, 28672
    buffer_load_dwordx4 a[56:59], v36, s[20:23], s67 offen offset:0 sc1
    buffer_load_dwordx4 a[60:63], v36, s[20:23], s67 offen offset:1024 sc1
    s_add_u32 s67, s67, 2048
    s_cmp_eq_u32 s67, s76
    s_cselect_b32 s66, s74, s66
    s_cselect_b32 s67, s75, s67
    s_cmp_lg_u32 s90, 0
    s_cbranch_scc1 L_kvslow
L_kvback:
    s_waitcnt vmcnt(14)
    v_mfma_f32_32x32x16_bf16 v[48:63], a[0:3], a[232:235], 0
    v_mfma_f32_32x32x16_bf16 v[48:63], a[4:7], a[236:239], v[48:63]
    buffer_store_dword v43, v40, s[20:23], s83 offen sc1
    v_mfma_f32_32x32x16_bf16 v[192:207], a[0:3], a[240:243], 0
    buffer_load_dwordx4 a[64:67], v2, s[20:23], s66 offen offset:0 sc1
    s_nop 8
    v_exp_f32 v48, v48
    v_exp_f32 v49, v49
    v_exp_f32 v50, v50
    v_exp_f32 v51, v51
    v_cvt_pk_bf16_f32 v240, v48, v49
    v_cvt_pk_bf16_f32 v241, v50, v51
    v_exp_f32 v52, v52
    v_exp_f32 v53, v53
    v_exp_f32 v54, v54
    v_exp_f32 v55, v55
    v_cvt_pk_bf16_f32 v242, v52, v53
    v_mfma_f32_32x32x16_bf16 v[192:207], a[4:7], a[244:247], v[192:207]
    s_waitcnt vmcnt(14)
    v_cvt_pk_bf16_f32 v243, v54, v55
    v_exp_f32 v56, v56
    v_exp_f32 v57, v57
    v_exp_f32 v58, v58
    v_exp_f32 v59, v59
    v_cvt_pk_bf16_f32 v244, v56, v57
    v_cvt_pk_bf16_f32 v245, v58, v59
    v_exp_f32 v60, v60
    v_exp_f32 v61, v61
    v_exp_f32 v62, v62
    v_exp_f32 v63, v63
    v_cvt_pk_bf16_f32 v246, v60, v61
    v_cvt_pk_bf16_f32 v247, v62, v63
    v_mfma_f32_32x32x16_bf16 v[48:63], a[0:3], a[248:251], 0
    buffer_load_dwordx4 a[68:71], v2, s[20:23], s66 offen offset:1024 sc1
    v_exp_f32 v192, v192
    v_exp_f32 v193, v193
    v_exp_f32 v194, v194
    v_exp_f32 v195, v195
    v_cvt_pk_bf16_f32 v248, v192, v193
    v_mfma_f32_32x32x16_bf16 v[160:175], a[8:11], v[240:243], 0
    buffer_store_dwordx4 v[112:115], v2, s[20:23], s58 offen offset:0 sc1
    v_cvt_pk_bf16_f32 v249, v194, v195
    v_exp_f32 v196, v196
    v_exp_f32 v197, v197
    v_exp_f32 v198, v198
    v_exp_f32 v199, v199
    v_mfma_f32_32x32x16_bf16 v[48:63], a[4:7], a[252:255], v[48:63]
    s_add_u32 m0, s73, 0
    v_cvt_pk_bf16_f32 v250, v196, v197
    v_cvt_pk_bf16_f32 v251, v198, v199
    v_exp_f32 v200, v200
    v_exp_f32 v201, v201
    v_exp_f32 v202, v202
    v_exp_f32 v203, v203
    v_cvt_pk_bf16_f32 v252, v200, v201
    v_mfma_f32_32x32x16_bf16 v[160:175], a[12:15], v[244:247], v[160:175]
    s_mov_b32 s55, 0x1d8000
    v_cvt_pk_bf16_f32 v253, v202, v203
    v_exp_f32 v204, v204
    v_exp_f32 v205, v205
    v_exp_f32 v206, v206
    v_exp_f32 v207, v207
    v_cvt_pk_bf16_f32 v254, v204, v205
    v_cvt_pk_bf16_f32 v255, v206, v207
    v_mfma_f32_32x32x16_bf16 v[192:207], a[0:3], a[224:227], 0
    buffer_load_dwordx4 a[72:75], v36, s[20:23], s67 offen offset:0 sc1
    v_exp_f32 v48, v48
    v_exp_f32 v49, v49
    v_exp_f32 v50, v50
    v_exp_f32 v51, v51
    v_cvt_pk_bf16_f32 v240, v48, v49
    v_mfma_f32_32x32x16_bf16 v[208:223], a[8:11], v[248:251], 0
    buffer_store_dwordx4 v[116:119], v2, s[20:23], s58 offen offset:1024 sc1
    v_cvt_pk_bf16_f32 v241, v50, v51
    v_exp_f32 v52, v52
    v_exp_f32 v53, v53
    v_exp_f32 v54, v54
    v_exp_f32 v55, v55
    v_mfma_f32_32x32x16_bf16 v[192:207], a[4:7], a[228:231], v[192:207]
    s_add_u32 s66, s66, 28672
    v_cvt_pk_bf16_f32 v242, v52, v53
    v_cvt_pk_bf16_f32 v243, v54, v55
    v_exp_f32 v56, v56
    v_exp_f32 v57, v57
    v_exp_f32 v58, v58
    v_exp_f32 v59, v59
    v_cvt_pk_bf16_f32 v244, v56, v57
    v_mfma_f32_32x32x16_bf16 v[208:223], a[12:15], v[252:255], v[208:223]
    s_waitcnt vmcnt(16)
    v_cvt_pk_bf16_f32 v245, v58, v59
    v_exp_f32 v60, v60
    v_exp_f32 v61, v61
    v_exp_f32 v62, v62
    v_exp_f32 v63, v63
    v_cvt_pk_bf16_f32 v246, v60, v61
    v_cvt_pk_bf16_f32 v247, v62, v63
    v_mfma_f32_32x32x16_bf16 v[48:63], a[16:19], a[232:235], 0
    buffer_load_dwordx4 a[76:79], v36, s[20:23], s67 offen offset:1024 sc1
    v_exp_f32 v192, v192
    v_exp_f32 v193, v193
    v_exp_f32 v194, v194
    v_exp_f32 v195, v195
    v_cvt_pk_bf16_f32 v248, v192, v193
    v_mfma_f32_32x32x16_bf16 v[224:239], a[8:11], v[240:243], 0
    buffer_store_dwordx4 v[128:131], v2, s[20:23], s59 offen offset:0 sc1
    v_cvt_pk_bf16_f32 v249, v194, v195
    v_exp_f32 v196, v196
    v_exp_f32 v197, v197
    v_exp_f32 v198, v198
    v_exp_f32 v199, v199
    v_mfma_f32_32x32x16_bf16 v[48:63], a[20:23], a[236:239], v[48:63]
    s_add_u32 s58, s58, 4096
    v_cvt_pk_bf16_f32 v250, v196, v197
    v_cvt_pk_bf16_f32 v251, v198, v199
    v_exp_f32 v200, v200
    v_exp_f32 v201, v201
    v_exp_f32 v202, v202
    v_exp_f32 v203, v203
    v_cvt_pk_bf16_f32 v252, v200, v201
    v_mfma_f32_32x32x16_bf16 v[224:239], a[12:15], v[244:247], v[224:239]
    s_add_u32 s67, s67, 2048
    v_cvt_pk_bf16_f32 v253, v202, v203
    v_exp_f32 v204, v204
    v_exp_f32 v205, v205
    v_exp_f32 v206, v206
    v_exp_f32 v207, v207
    v_cvt_pk_bf16_f32 v254, v204, v205
    v_cvt_pk_bf16_f32 v255, v206, v207
    v_mfma_f32_32x32x16_bf16 v[192:207], a[16:19], a[240:243], 0
    buffer_load_dwordx4 a[0:3], v2, s[20:23], s66 offen offset:0 sc1
    v_exp_f32 v48, v48
    v_exp_f32 v49, v49
    v_exp_f32 v50, v50
    v_exp_f32 v51, v51
    v_cvt_pk_bf16_f32 v240, v48, v49
    v_mfma_f32_32x32x16_bf16 v[144:159], a[8:11], v[248:251], 0
    buffer_store_dwordx4 v[132:135], v2, s[20:23], s59 offen offset:1024 sc1
    v_cvt_pk_bf16_f32 v241, v50, v51
    v_exp_f32 v52, v52
    v_exp_f32 v53, v53
    v_exp_f32 v54, v54
    v_exp_f32 v55, v55
    v_mfma_f32_32x32x16_bf16 v[192:207], a[20:23], a[244:247], v[192:207]
    s_add_u32 s59, s59, 4096
    v_cvt_pk_bf16_f32 v242, v52, v53
    v_cvt_pk_bf16_f32 v243, v54, v55
    v_exp_f32 v56, v56
    v_exp_f32 v57, v57
    v_exp_f32 v58, v58
    v_exp_f32 v59, v59
    v_cvt_pk_bf16_f32 v244, v56, v57
    v_mfma_f32_32x32x16_bf16 v[144:159], a[12:15], v[252:255], v[144:159]
    s_waitcnt vmcnt(18)
    v_cvt_pk_bf16_f32 v245, v58, v59
    v_exp_f32 v60, v60
    v_exp_f32 v61, v61
    v_exp_f32 v62, v62
    v_exp_f32 v63, v63
    v_cvt_pk_bf16_f32 v246, v60, v61
    v_cvt_pk_bf16_f32 v247, v62, v63
    v_mfma_f32_32x32x16_bf16 v[48:63], a[16:19], a[248:251], 0
    buffer_load_dwordx4 a[4:7], v2, s[20:23], s66 offen offset:1024 sc1
    v_exp_f32 v192, v192
    v_exp_f32 v193, v193
    v_exp_f32 v194, v194
    v_exp_f32 v195, v195
    v_cvt_pk_bf16_f32 v248, v192, v193
    v_mfma_f32_32x32x16_bf16 v[160:175], a[24:27], v[240:243], v[160:175]
    buffer_store_dwordx4 v[96:99], v2, s[20:23], s58 offen offset:0 sc1
    v_cvt_pk_bf16_f32 v249, v194, v195
    v_exp_f32 v196, v196
    v_exp_f32 v197, v197
    v_exp_f32 v198, v198
    v_exp_f32 v199, v199
    v_mfma_f32_32x32x16_bf16 v[48:63], a[20:23], a[252:255], v[48:63]
    s_add_u32 s66, s66, 28672
    v_cvt_pk_bf16_f32 v250, v196, v197
    v_cvt_pk_bf16_f32 v251, v198, v199
    v_exp_f32 v200, v200
    v_exp_f32 v201, v201
    v_exp_f32 v202, v202
    v_exp_f32 v203, v203
    v_cvt_pk_bf16_f32 v252, v200, v201
    v_mfma_f32_32x32x16_bf16 v[160:175], a[28:31], v[244:247], v[160:175]
    v_cvt_pk_bf16_f32 v253, v202, v203
    v_exp_f32 v204, v204
    v_exp_f32 v205, v205
    v_exp_f32 v206, v206
    v_exp_f32 v207, v207
    v_cvt_pk_bf16_f32 v254, v204, v205
    v_cvt_pk_bf16_f32 v255, v206, v207
    v_mfma_f32_32x32x16_bf16 v[192:207], a[16:19], a[224:227], 0
    buffer_load_dwordx4 a[8:11], v36, s[20:23], s67 offen offset:0 sc1
    v_exp_f32 v48, v48
    v_exp_f32 v49, v49
    v_exp_f32 v50, v50
    v_exp_f32 v51, v51
    v_cvt_pk_bf16_f32 v240, v48, v49
    v_mfma_f32_32x32x16_bf16 v[208:223], a[24:27], v[248:251], v[208:223]
    buffer_store_dwordx4 v[100:103], v2, s[20:23], s58 offen offset:1024 sc1
    v_cvt_pk_bf16_f32 v241, v50, v51
    v_exp_f32 v52, v52
    v_exp_f32 v53, v53
    v_exp_f32 v54, v54
    v_exp_f32 v55, v55
    v_mfma_f32_32x32x16_bf16 v[192:207], a[20:23], a[228:231], v[192:207]
    v_cvt_pk_bf16_f32 v242, v52, v53
    v_cvt_pk_bf16_f32 v243, v54, v55
    v_exp_f32 v56, v56
    v_exp_f32 v57, v57
    v_exp_f32 v58, v58
    v_exp_f32 v59, v59
    v_cvt_pk_bf16_f32 v244, v56, v57
    v_mfma_f32_32x32x16_bf16 v[208:223], a[28:31], v[252:255], v[208:223]
    s_waitcnt vmcnt(20)
    v_cvt_pk_bf16_f32 v245, v58, v59
    v_exp_f32 v60, v60
    v_exp_f32 v61, v61
    v_exp_f32 v62, v62
    v_exp_f32 v63, v63
    v_cvt_pk_bf16_f32 v246, v60, v61
    v_cvt_pk_bf16_f32 v247, v62, v63
    v_mfma_f32_32x32x16_bf16 v[48:63], a[32:35], a[232:235], 0
    buffer_load_dwordx4 a[12:15], v36, s[20:23], s67 offen offset:1024 sc1
    v_exp_f32 v192, v192
    v_exp_f32 v193, v193
    v_exp_f32 v194, v194
    v_exp_f32 v195, v195
    v_cvt_pk_bf16_f32 v248, v192, v193
    v_mfma_f32_32x32x16_bf16 v[224:239], a[24:27], v[240:243], v[224:239]
    buffer_store_dwordx4 v[104:107], v2, s[20:23], s59 offen offset:0 sc1
    v_cvt_pk_bf16_f32 v249, v194, v195
    v_exp_f32 v196, v196
    v_exp_f32 v197, v197
    v_exp_f32 v198, v198
    v_exp_f32 v199, v199
    v_mfma_f32_32x32x16_bf16 v[48:63], a[36:39], a[236:239], v[48:63]
    s_add_u32 s67, s67, 2048
    v_cvt_pk_bf16_f32 v250, v196, v197
    v_cvt_pk_bf16_f32 v251, v198, v199
    v_exp_f32 v200, v200
    v_exp_f32 v201, v201
    v_exp_f32 v202, v202
    v_exp_f32 v203, v203
    v_cvt_pk_bf16_f32 v252, v200, v201
    v_mfma_f32_32x32x16_bf16 v[224:239], a[28:31], v[244:247], v[224:239]
    s_cmp_eq_u32 s67, s76
    v_cvt_pk_bf16_f32 v253, v202, v203
    v_exp_f32 v204, v204
    v_exp_f32 v205, v205
    v_exp_f32 v206, v206
    v_exp_f32 v207, v207
    v_cvt_pk_bf16_f32 v254, v204, v205
    v_cvt_pk_bf16_f32 v255, v206, v207
    v_mfma_f32_32x32x16_bf16 v[192:207], a[32:35], a[240:243], 0
    s_cselect_b32 s66, s74, s66
    buffer_load_dwordx4 a[16:19], v2, s[20:23], s66 offen offset:0 sc1
    v_exp_f32 v48, v48
    v_exp_f32 v49, v49
    v_exp_f32 v50, v50
    v_exp_f32 v51, v51
    v_cvt_pk_bf16_f32 v240, v48, v49
    v_mfma_f32_32x32x16_bf16 v[144:159], a[24:27], v[248:251], v[144:159]
    buffer_store_dwordx4 v[108:111], v2, s[20:23], s59 offen offset:1024 sc1
    v_cvt_pk_bf16_f32 v241, v50, v51
    v_exp_f32 v52, v52
    v_exp_f32 v53, v53
    v_exp_f32 v54, v54
    v_exp_f32 v55, v55
    v_mfma_f32_32x32x16_bf16 v[192:207], a[36:39], a[244:247], v[192:207]
    s_cselect_b32 s67, s75, s67
    v_cvt_pk_bf16_f32 v242, v52, v53
    v_cvt_pk_bf16_f32 v243, v54, v55
    v_exp_f32 v56, v56
    v_exp_f32 v57, v57
    v_exp_f32 v58, v58
    v_exp_f32 v59, v59
    v_cvt_pk_bf16_f32 v244, v56, v57
    v_mfma_f32_32x32x16_bf16 v[144:159], a[28:31], v[252:255], v[144:159]
    s_waitcnt vmcnt(22)
    v_cvt_pk_bf16_f32 v245, v58, v59
    v_exp_f32 v60, v60
    v_exp_f32 v61, v61
    v_exp_f32 v62, v62
    v_exp_f32 v63, v63
    v_cvt_pk_bf16_f32 v246, v60, v61
    v_cvt_pk_bf16_f32 v247, v62, v63
    v_mfma_f32_32x32x16_bf16 v[48:63], a[32:35], a[248:251], 0
    buffer_load_dwordx4 a[20:23], v2, s[20:23], s66 offen offset:1024 sc1
    v_exp_f32 v192, v192
    v_exp_f32 v193, v193
    v_exp_f32 v194, v194
    v_exp_f32 v195, v195
    v_cvt_pk_bf16_f32 v248, v192, v193
    v_mfma_f32_32x32x16_bf16 v[160:175], a[40:43], v[240:243], v[160:175]
    buffer_load_dwordx4 v176, s[28:31], s70 offen offset:0  lds
    v_cvt_pk_bf16_f32 v249, v194, v195
    v_exp_f32 v196, v196
    v_exp_f32 v197, v197
    v_exp_f32 v198, v198
    v_exp_f32 v199, v199
    v_mfma_f32_32x32x16_bf16 v[48:63], a[36:39], a[252:255], v[48:63]
    s_add_u32 s66, s66, 28672
    v_cvt_pk_bf16_f32 v250, v196, v197
    v_cvt_pk_bf16_f32 v251, v198, v199
    v_exp_f32 v200, v200
    v_exp_f32 v201, v201
    v_exp_f32 v202, v202
    v_exp_f32 v203, v203
    v_cvt_pk_bf16_f32 v252, v200, v201
    v_mfma_f32_32x32x16_bf16 v[160:175], a[44:47], v[244:247], v[160:175]
    v_cvt_pk_bf16_f32 v253, v202, v203
    v_exp_f32 v204, v204
    v_exp_f32 v205, v205
    v_exp_f32 v206, v206
    v_exp_f32 v207, v207
    v_cvt_pk_bf16_f32 v254, v204, v205
    v_cvt_pk_bf16_f32 v255, v206, v207
    v_mfma_f32_32x32x16_bf16 v[192:207], a[32:35], a[224:227], 0
    buffer_load_dwordx4 a[24:27], v36, s[20:23], s67 offen offset:0 sc1
    v_exp_f32 v48, v48
    v_exp_f32 v49, v49
    v_exp_f32 v50, v50
    v_exp_f32 v51, v51
    v_cvt_pk_bf16_f32 v240, v48, v49
    v_cvt_pk_bf16_f32 v241, v50, v51
    v_mfma_f32_32x32x16_bf16 v[208:223], a[40:43], v[248:251], v[208:223]
    buffer_load_dwordx4 v177, s[28:31], s70 offen offset:1024  lds
    v_exp_f32 v52, v52
    v_exp_f32 v53, v53
    v_exp_f32 v54, v54
    v_exp_f32 v55, v55
    v_cvt_pk_bf16_f32 v242, v52, v53
    v_mfma_f32_32x32x16_bf16 v[192:207], a[36:39], a[228:231], v[192:207]
    s_waitcnt vmcnt(24)
    v_cvt_pk_bf16_f32 v243, v54, v55
    v_exp_f32 v56, v56
    v_exp_f32 v57, v57
    v_exp_f32 v58, v58
    v_exp_f32 v59, v59
    v_cvt_pk_bf16_f32 v244, v56, v57
    v_cvt_pk_bf16_f32 v245, v58, v59
    v_mfma_f32_32x32x16_bf16 v[208:223], a[44:47], v[252:255], v[208:223]
    buffer_load_dwordx4 v178, s[28:31], s70 offen offset:2048  lds
    v_exp_f32 v60, v60
    v_exp_f32 v61, v61
    v_exp_f32 v62, v62
    v_exp_f32 v63, v63
    v_cvt_pk_bf16_f32 v246, v60, v61
    v_cvt_pk_bf16_f32 v247, v62, v63
    v_mfma_f32_32x32x16_bf16 v[48:63], a[48:51], a[232:235], 0
    buffer_load_dwordx4 a[28:31], v36, s[20:23], s67 offen offset:1024 sc1
    v_exp_f32 v192, v192
    v_exp_f32 v193, v193
    v_exp_f32 v194, v194
    v_exp_f32 v195, v195
    v_cvt_pk_bf16_f32 v248, v192, v193
    v_cvt_pk_bf16_f32 v249, v194, v195
    v_mfma_f32_32x32x16_bf16 v[224:239], a[40:43], v[240:243], v[224:239]
    buffer_load_dwordx4 v179, s[28:31], s70 offen offset:3072  lds
    v_exp_f32 v196, v196
    v_exp_f32 v197, v197
    v_exp_f32 v198, v198
    v_exp_f32 v199, v199
    v_cvt_pk_bf16_f32 v250, v196, v197
    v_mfma_f32_32x32x16_bf16 v[48:63], a[52:55], a[236:239], v[48:63]
    s_add_u32 s67, s67, 2048
    v_cvt_pk_bf16_f32 v251, v198, v199
    v_exp_f32 v200, v200
    v_exp_f32 v201, v201
    v_exp_f32 v202, v202
    v_exp_f32 v203, v203
    v_cvt_pk_bf16_f32 v252, v200, v201
    v_cvt_pk_bf16_f32 v253, v202, v203
    v_mfma_f32_32x32x16_bf16 v[224:239], a[44:47], v[244:247], v[224:239]
    s_add_u32 s70, s70, 28672
    s_add_u32 m0, s73, 4096
    s_nop 0
    buffer_load_dwordx4 v176, s[28:31], s70 offen offset:0  lds
    v_exp_f32 v204, v204
    v_exp_f32 v205, v205
    v_exp_f32 v206, v206
    v_exp_f32 v207, v207
    v_cvt_pk_bf16_f32 v254, v204, v205
    v_cvt_pk_bf16_f32 v255, v206, v207
    v_mfma_f32_32x32x16_bf16 v[192:207], a[48:51], a[240:243], 0
    buffer_load_dwordx4 a[32:35], v2, s[20:23], s66 offen offset:0 sc1
    v_exp_f32 v48, v48
    v_exp_f32 v49, v49
    v_exp_f32 v50, v50
    v_exp_f32 v51, v51
    v_cvt_pk_bf16_f32 v240, v48, v49
    v_cvt_pk_bf16_f32 v241, v50, v51
    v_mfma_f32_32x32x16_bf16 v[144:159], a[40:43], v[248:251], v[144:159]
    buffer_load_dwordx4 v177, s[28:31], s70 offen offset:1024  lds
    v_exp_f32 v52, v52
    v_exp_f32 v53, v53
    v_exp_f32 v54, v54
    v_exp_f32 v55, v55
    v_cvt_pk_bf16_f32 v242, v52, v53
    v_mfma_f32_32x32x16_bf16 v[192:207], a[52:55], a[244:247], v[192:207]
    s_waitcnt vmcnt(28)
    v_cvt_pk_bf16_f32 v243, v54, v55
    v_exp_f32 v56, v56
    v_exp_f32 v57, v57
    v_exp_f32 v58, v58
    v_exp_f32 v59, v59
    v_cvt_pk_bf16_f32 v244, v56, v57
    v_cvt_pk_bf16_f32 v245, v58, v59
    v_mfma_f32_32x32x16_bf16 v[144:159], a[44:47], v[252:255], v[144:159]
    s_waitcnt vmcnt(10)
    s_barrier
    buffer_store_dword v3, v4, s[20:23], s55 offen sc1
    v_exp_f32 v60, v60
    v_exp_f32 v61, v61
    v_exp_f32 v62, v62
    v_exp_f32 v63, v63
    v_cvt_pk_bf16_f32 v246, v60, v61
    v_cvt_pk_bf16_f32 v247, v62, v63
    v_mfma_f32_32x32x16_bf16 v[48:63], a[48:51], a[248:251], 0
    buffer_load_dwordx4 a[36:39], v2, s[20:23], s66 offen offset:1024 sc1
    v_exp_f32 v192, v192
    v_exp_f32 v193, v193
    v_exp_f32 v194, v194
    v_exp_f32 v195, v195
    v_cvt_pk_bf16_f32 v248, v192, v193
    v_mfma_f32_32x32x16_bf16 v[160:175], a[56:59], v[240:243], v[160:175]
    buffer_load_dwordx4 v178, s[28:31], s70 offen offset:2048  lds
    v_cvt_pk_bf16_f32 v249, v194, v195
    v_exp_f32 v196, v196
    v_exp_f32 v197, v197
    v_exp_f32 v198, v198
    v_exp_f32 v199, v199
    v_mfma_f32_32x32x16_bf16 v[48:63], a[52:55], a[252:255], v[48:63]
    s_lshr_b32 s55, s85, 2
    v_cvt_pk_bf16_f32 v250, v196, v197
    v_cvt_pk_bf16_f32 v251, v198, v199
    v_exp_f32 v200, v200
    v_exp_f32 v201, v201
    v_exp_f32 v202, v202
    v_exp_f32 v203, v203
    v_cvt_pk_bf16_f32 v252, v200, v201
    v_mfma_f32_32x32x16_bf16 v[160:175], a[60:63], v[244:247], v[160:175]
    s_lshl_b32 s55, s55, 11
    v_cvt_pk_bf16_f32 v253, v202, v203
    v_exp_f32 v204, v204
    v_exp_f32 v205, v205
    v_exp_f32 v206, v206
    v_exp_f32 v207, v207
    v_cvt_pk_bf16_f32 v254, v204, v205
    v_cvt_pk_bf16_f32 v255, v206, v207
    v_mfma_f32_32x32x16_bf16 v[192:207], a[48:51], a[224:227], 0
    buffer_load_dwordx4 a[40:43], v36, s[20:23], s67 offen offset:0 sc1
    v_exp_f32 v48, v48
    v_exp_f32 v49, v49
    v_exp_f32 v50, v50
    v_exp_f32 v51, v51
    v_cvt_pk_bf16_f32 v240, v48, v49
    v_cvt_pk_bf16_f32 v241, v50, v51
    v_mfma_f32_32x32x16_bf16 v[208:223], a[56:59], v[248:251], v[208:223]
    buffer_load_dwordx4 v179, s[28:31], s70 offen offset:3072  lds
    v_exp_f32 v52, v52
    v_exp_f32 v53, v53
    v_exp_f32 v54, v54
    v_exp_f32 v55, v55
    v_cvt_pk_bf16_f32 v242, v52, v53
    v_mfma_f32_32x32x16_bf16 v[192:207], a[52:55], a[228:231], v[192:207]
    s_add_u32 s55, s55, 0x1d8000
    v_cvt_pk_bf16_f32 v243, v54, v55
    v_exp_f32 v56, v56
    v_exp_f32 v57, v57
    v_exp_f32 v58, v58
    v_exp_f32 v59, v59
    v_cvt_pk_bf16_f32 v244, v56, v57
    v_cvt_pk_bf16_f32 v245, v58, v59
    v_mfma_f32_32x32x16_bf16 v[208:223], a[60:63], v[252:255], v[208:223]
    s_add_u32 s66, s66, 28672
    s_add_u32 s70, s70, 28672
    s_cmp_eq_u32 s70, s84
    s_cselect_b32 s70, s79, s70
    s_add_u32 m0, s71, 65536
    s_nop 0
    buffer_load_dwordx4 v176, s[32:35], s87 offen offset:0  lds
    v_exp_f32 v60, v60
    v_exp_f32 v61, v61
    v_exp_f32 v62, v62
    v_exp_f32 v63, v63
    v_cvt_pk_bf16_f32 v246, v60, v61
    v_cvt_pk_bf16_f32 v247, v62, v63
    v_mfma_f32_32x32x16_bf16 v[48:63], a[64:67], a[232:235], 0
    buffer_load_dwordx4 a[44:47], v36, s[20:23], s67 offen offset:1024 sc1
    v_exp_f32 v192, v192
    v_exp_f32 v193, v193
    v_exp_f32 v194, v194
    v_exp_f32 v195, v195
    v_cvt_pk_bf16_f32 v248, v192, v193
    v_cvt_pk_bf16_f32 v249, v194, v195
    v_mfma_f32_32x32x16_bf16 v[224:239], a[56:59], v[240:243], v[224:239]
    buffer_load_dwordx4 v177, s[32:35], s87 offen offset:1024  lds
    v_exp_f32 v196, v196
    v_exp_f32 v197, v197
    v_exp_f32 v198, v198
    v_exp_f32 v199, v199
    v_cvt_pk_bf16_f32 v250, v196, v197
    v_mfma_f32_32x32x16_bf16 v[48:63], a[68:71], a[236:239], v[48:63]
    s_add_u32 s67, s67, 2048
    v_cvt_pk_bf16_f32 v251, v198, v199
    v_exp_f32 v200, v200
    v_exp_f32 v201, v201
    v_exp_f32 v202, v202
    v_exp_f32 v203, v203
    v_cvt_pk_bf16_f32 v252, v200, v201
    v_cvt_pk_bf16_f32 v253, v202, v203
    v_mfma_f32_32x32x16_bf16 v[224:239], a[60:63], v[244:247], v[224:239]
    buffer_load_dwordx4 v178, s[32:35], s87 offen offset:2048  lds
    v_exp_f32 v204, v204
    v_exp_f32 v205, v205
    v_exp_f32 v206, v206
    v_exp_f32 v207, v207
    v_cvt_pk_bf16_f32 v254, v204, v205
    v_cvt_pk_bf16_f32 v255, v206, v207
    v_mfma_f32_32x32x16_bf16 v[192:207], a[64:67], a[240:243], 0
    s_cmp_eq_u32 s67, s76
    s_cselect_b32 s66, s74, s66
    buffer_load_dwordx4 a[48:51], v2, s[20:23], s66 offen offset:0 sc1
    v_exp_f32 v48, v48
    v_exp_f32 v49, v49
    v_exp_f32 v50, v50
    v_exp_f32 v51, v51
    v_cvt_pk_bf16_f32 v240, v48, v49
    v_cvt_pk_bf16_f32 v241, v50, v51
    v_mfma_f32_32x32x16_bf16 v[144:159], a[56:59], v[248:251], v[144:159]
    buffer_load_dwordx4 v179, s[32:35], s87 offen offset:3072  lds
    v_exp_f32 v52, v52
    v_exp_f32 v53, v53
    v_exp_f32 v54, v54
    v_exp_f32 v55, v55
    v_cvt_pk_bf16_f32 v242, v52, v53
    v_mfma_f32_32x32x16_bf16 v[192:207], a[68:71], a[244:247], v[192:207]
    s_cselect_b32 s67, s75, s67
    v_cvt_pk_bf16_f32 v243, v54, v55
    v_exp_f32 v56, v56
    v_exp_f32 v57, v57
    v_exp_f32 v58, v58
    v_exp_f32 v59, v59
    v_cvt_pk_bf16_f32 v244, v56, v57
    v_cvt_pk_bf16_f32 v245, v58, v59
    v_mfma_f32_32x32x16_bf16 v[144:159], a[60:63], v[252:255], v[144:159]
    s_add_u32 s87, s87, 100352
    s_add_u32 m0, s71, 69632
    s_nop 0
    buffer_load_dwordx4 v176, s[32:35], s87 offen offset:0  lds
    v_exp_f32 v60, v60
    v_exp_f32 v61, v61
    v_exp_f32 v62, v62
    v_exp_f32 v63, v63
    v_cvt_pk_bf16_f32 v246, v60, v61
    v_cvt_pk_bf16_f32 v247, v62, v63
    v_mfma_f32_32x32x16_bf16 v[48:63], a[64:67], a[248:251], 0
    buffer_load_dwordx4 a[52:55], v2, s[20:23], s66 offen offset:1024 sc1
    v_exp_f32 v192, v192
    v_exp_f32 v193, v193
    v_exp_f32 v194, v194
    v_exp_f32 v195, v195
    v_cvt_pk_bf16_f32 v248, v192, v193
    v_mfma_f32_32x32x16_bf16 v[160:175], a[72:75], v[240:243], v[160:175]
    buffer_load_dwordx4 v177, s[32:35], s87 offen offset:1024  lds
    v_cvt_pk_bf16_f32 v249, v194, v195
    v_exp_f32 v196, v196
    v_exp_f32 v197, v197
    v_exp_f32 v198, v198
    v_exp_f32 v199, v199
    v_mfma_f32_32x32x16_bf16 v[48:63], a[68:71], a[252:255], v[48:63]
    s_add_u32 s66, s66, 28672
    v_cvt_pk_bf16_f32 v250, v196, v197
    v_cvt_pk_bf16_f32 v251, v198, v199
    v_exp_f32 v200, v200
    v_exp_f32 v201, v201
    v_exp_f32 v202, v202
    v_exp_f32 v203, v203
    v_cvt_pk_bf16_f32 v252, v200, v201
    v_mfma_f32_32x32x16_bf16 v[160:175], a[76:79], v[244:247], v[160:175]
    v_cvt_pk_bf16_f32 v253, v202, v203
    v_exp_f32 v204, v204
    v_exp_f32 v205, v205
    v_exp_f32 v206, v206
    v_exp_f32 v207, v207
    v_cvt_pk_bf16_f32 v254, v204, v205
    v_cvt_pk_bf16_f32 v255, v206, v207
    v_mfma_f32_32x32x16_bf16 v[192:207], a[64:67], a[224:227], 0
    buffer_load_dwordx4 a[56:59], v36, s[20:23], s67 offen offset:0 sc1
    v_exp_f32 v48, v48
    v_exp_f32 v49, v49
    v_exp_f32 v50, v50
    v_exp_f32 v51, v51
    v_cvt_pk_bf16_f32 v240, v48, v49
    v_cvt_pk_bf16_f32 v241, v50, v51
    v_mfma_f32_32x32x16_bf16 v[208:223], a[72:75], v[248:251], v[208:223]
    buffer_load_dwordx4 v178, s[32:35], s87 offen offset:2048  lds
    v_exp_f32 v52, v52
    v_exp_f32 v53, v53
    v_exp_f32 v54, v54
    v_exp_f32 v55, v55
    v_cvt_pk_bf16_f32 v242, v52, v53
    v_mfma_f32_32x32x16_bf16 v[192:207], a[68:71], a[228:231], v[192:207]
    v_cvt_pk_bf16_f32 v243, v54, v55
    v_exp_f32 v56, v56
    v_exp_f32 v57, v57
    v_exp_f32 v58, v58
    v_exp_f32 v59, v59
    v_cvt_pk_bf16_f32 v244, v56, v57
    v_cvt_pk_bf16_f32 v245, v58, v59
    v_mfma_f32_32x32x16_bf16 v[208:223], a[76:79], v[252:255], v[208:223]
    buffer_load_dwordx4 v179, s[32:35], s87 offen offset:3072  lds
    v_exp_f32 v60, v60
    v_exp_f32 v61, v61
    v_exp_f32 v62, v62
    v_exp_f32 v63, v63
    v_cvt_pk_bf16_f32 v246, v60, v61
    v_cvt_pk_bf16_f32 v247, v62, v63
    v_mfma_f32_32x32x16_bf16 v[48:63], a[0:3], a[232:235], 0
    buffer_load_dwordx4 a[60:63], v36, s[20:23], s67 offen offset:1024 sc1
    v_exp_f32 v192, v192
    v_exp_f32 v193, v193
    v_exp_f32 v194, v194
    v_exp_f32 v195, v195
    v_cvt_pk_bf16_f32 v248, v192, v193
    v_cvt_pk_bf16_f32 v249, v194, v195
    v_mfma_f32_32x32x16_bf16 v[224:239], a[72:75], v[240:243], v[224:239]
    s_add_u32 s87, s87, 100352
    s_add_u32 m0, s71, 73728
    s_nop 0
    buffer_load_dwordx4 v176, s[32:35], s87 offen offset:0  lds
    v_exp_f32 v196, v196
    v_exp_f32 v197, v197
    v_exp_f32 v198, v198
    v_exp_f32 v199, v199
    v_cvt_pk_bf16_f32 v250, v196, v197
    v_mfma_f32_32x32x16_bf16 v[48:63], a[4:7], a[236:239], v[48:63]
    s_add_u32 s67, s67, 2048
    v_cvt_pk_bf16_f32 v251, v198, v199
    v_exp_f32 v200, v200
    v_exp_f32 v201, v201
    v_exp_f32 v202, v202
    v_exp_f32 v203, v203
    v_cvt_pk_bf16_f32 v252, v200, v201
    v_cvt_pk_bf16_f32 v253, v202, v203
    v_mfma_f32_32x32x16_bf16 v[224:239], a[76:79], v[244:247], v[224:239]
    buffer_load_dwordx4 v177, s[32:35], s87 offen offset:1024  lds
    v_exp_f32 v204, v204
    v_exp_f32 v205, v205
    v_exp_f32 v206, v206
    v_exp_f32 v207, v207
    v_cvt_pk_bf16_f32 v254, v204, v205
    v_cvt_pk_bf16_f32 v255, v206, v207
    v_mfma_f32_32x32x16_bf16 v[192:207], a[0:3], a[240:243], 0
    buffer_load_dwordx4 a[64:67], v2, s[20:23], s66 offen offset:0 sc1
    v_exp_f32 v48, v48
    v_exp_f32 v49, v49
    v_exp_f32 v50, v50
    v_exp_f32 v51, v51
    v_cvt_pk_bf16_f32 v240, v48, v49
    v_cvt_pk_bf16_f32 v241, v50, v51
    v_mfma_f32_32x32x16_bf16 v[144:159], a[72:75], v[248:251], v[144:159]
    buffer_load_dwordx4 v178, s[32:35], s87 offen offset:2048  lds
    v_exp_f32 v52, v52
    v_exp_f32 v53, v53
    v_exp_f32 v54, v54
    v_exp_f32 v55, v55
    v_cvt_pk_bf16_f32 v242, v52, v53
    v_mfma_f32_32x32x16_bf16 v[192:207], a[4:7], a[244:247], v[192:207]
    v_cvt_pk_bf16_f32 v243, v54, v55
    v_exp_f32 v56, v56
    v_exp_f32 v57, v57
    v_exp_f32 v58, v58
    v_exp_f32 v59, v59
    v_cvt_pk_bf16_f32 v244, v56, v57
    v_cvt_pk_bf16_f32 v245, v58, v59
    v_mfma_f32_32x32x16_bf16 v[144:159], a[76:79], v[252:255], v[144:159]
    buffer_load_dword v35, v38, s[20:23], s55 offen sc1
    v_exp_f32 v60, v60
    v_exp_f32 v61, v61
    v_exp_f32 v62, v62
    v_exp_f32 v63, v63
    v_cvt_pk_bf16_f32 v246, v60, v61
    v_cvt_pk_bf16_f32 v247, v62, v63
    v_mfma_f32_32x32x16_bf16 v[48:63], a[0:3], a[248:251], 0
    buffer_load_dwordx4 a[68:71], v2, s[20:23], s66 offen offset:1024 sc1
    v_exp_f32 v192, v192
    v_exp_f32 v193, v193
    v_exp_f32 v194, v194
    v_exp_f32 v195, v195
    v_cvt_pk_bf16_f32 v248, v192, v193
    v_mfma_f32_32x32x16_bf16 v[160:175], a[8:11], v[240:243], v[160:175]
    buffer_load_dwordx4 v179, s[32:35], s87 offen offset:3072  lds
    v_cvt_pk_bf16_f32 v249, v194, v195
    v_exp_f32 v196, v196
    v_exp_f32 v197, v197
    v_exp_f32 v198, v198
    v_exp_f32 v199, v199
    v_mfma_f32_32x32x16_bf16 v[48:63], a[4:7], a[252:255], v[48:63]
    s_add_u32 s66, s66, 28672
    v_cvt_pk_bf16_f32 v250, v196, v197
    v_cvt_pk_bf16_f32 v251, v198, v199
    v_exp_f32 v200, v200
    v_exp_f32 v201, v201
    v_exp_f32 v202, v202
    v_exp_f32 v203, v203
    v_cvt_pk_bf16_f32 v252, v200, v201
    v_mfma_f32_32x32x16_bf16 v[160:175], a[12:15], v[244:247], v[160:175]
    s_add_u32 s87, s87, 100352
    v_cvt_pk_bf16_f32 v253, v202, v203
    v_exp_f32 v204, v204
    v_exp_f32 v205, v205
    v_exp_f32 v206, v206
    v_exp_f32 v207, v207
    v_cvt_pk_bf16_f32 v254, v204, v205
    v_cvt_pk_bf16_f32 v255, v206, v207
    v_mfma_f32_32x32x16_bf16 v[192:207], a[0:3], a[224:227], 0
    buffer_load_dwordx4 a[72:75], v36, s[20:23], s67 offen offset:0 sc1
    v_exp_f32 v48, v48
    v_exp_f32 v49, v49
    v_exp_f32 v50, v50
    v_exp_f32 v51, v51
    v_cvt_pk_bf16_f32 v240, v48, v49
    v_cvt_pk_bf16_f32 v241, v50, v51
    v_mfma_f32_32x32x16_bf16 v[208:223], a[8:11], v[248:251], v[208:223]
    s_add_u32 m0, s71, 77824
    s_nop 0
    buffer_load_dwordx4 v176, s[32:35], s87 offen offset:0  lds
    v_exp_f32 v52, v52
    v_exp_f32 v53, v53
    v_exp_f32 v54, v54
    v_exp_f32 v55, v55
    v_cvt_pk_bf16_f32 v242, v52, v53
    v_mfma_f32_32x32x16_bf16 v[192:207], a[4:7], a[228:231], v[192:207]
    s_waitcnt vmcnt(36)
    v_cvt_pk_bf16_f32 v243, v54, v55
    v_exp_f32 v56, v56
    v_exp_f32 v57, v57
    v_exp_f32 v58, v58
    v_exp_f32 v59, v59
    v_cvt_pk_bf16_f32 v244, v56, v57
    v_cvt_pk_bf16_f32 v245, v58, v59
    v_mfma_f32_32x32x16_bf16 v[208:223], a[12:15], v[252:255], v[208:223]
    buffer_load_dwordx4 v177, s[32:35], s87 offen offset:1024  lds
    v_exp_f32 v60, v60
    v_exp_f32 v61, v61
    v_exp_f32 v62, v62
    v_exp_f32 v63, v63
    v_cvt_pk_bf16_f32 v246, v60, v61
    v_cvt_pk_bf16_f32 v247, v62, v63
    v_mfma_f32_32x32x16_bf16 v[48:63], a[16:19], a[232:235], 0
    buffer_load_dwordx4 a[76:79], v36, s[20:23], s67 offen offset:1024 sc1
    v_exp_f32 v192, v192
    v_exp_f32 v193, v193
    v_exp_f32 v194, v194
    v_exp_f32 v195, v195
    v_cvt_pk_bf16_f32 v248, v192, v193
    v_cvt_pk_bf16_f32 v249, v194, v195
    v_mfma_f32_32x32x16_bf16 v[224:239], a[8:11], v[240:243], v[224:239]
    buffer_load_dwordx4 v178, s[32:35], s87 offen offset:2048  lds
    v_exp_f32 v196, v196
    v_exp_f32 v197, v197
    v_exp_f32 v198, v198
    v_exp_f32 v199, v199
    v_cvt_pk_bf16_f32 v250, v196, v197
    v_mfma_f32_32x32x16_bf16 v[48:63], a[20:23], a[236:239], v[48:63]
    s_add_u32 s67, s67, 2048
    v_cvt_pk_bf16_f32 v251, v198, v199
    v_exp_f32 v200, v200
    v_exp_f32 v201, v201
    v_exp_f32 v202, v202
    v_exp_f32 v203, v203
    v_cvt_pk_bf16_f32 v252, v200, v201
    v_cvt_pk_bf16_f32 v253, v202, v203
    v_mfma_f32_32x32x16_bf16 v[224:239], a[12:15], v[244:247], v[224:239]
    buffer_load_dwordx4 v179, s[32:35], s87 offen offset:3072  lds
    v_exp_f32 v204, v204
    v_exp_f32 v205, v205
    v_exp_f32 v206, v206
    v_exp_f32 v207, v207
    v_cvt_pk_bf16_f32 v254, v204, v205
    v_cvt_pk_bf16_f32 v255, v206, v207
    s_cmp_eq_u32 s67, s76
    s_cselect_b32 s66, s74, s66
    s_cselect_b32 s67, s75, s67
    s_waitcnt vmcnt(8)
    v_cmp_ne_u32 vcc, v35, v3
    s_and_b32 vcc_lo, vcc_lo, 0x7f7f
    s_cbranch_scc1 L_hslow
L_hback:
    v_mfma_f32_32x32x16_bf16 v[192:207], a[16:19], a[240:243], 0
    buffer_load_dwordx4 a[0:3], v2, s[20:23], s66 offen offset:0 sc1
    v_exp_f32 v48, v48
    v_exp_f32 v49, v49
    v_exp_f32 v50, v50
    v_exp_f32 v51, v51
    v_cvt_pk_bf16_f32 v240, v48, v49
    v_cvt_pk_bf16_f32 v241, v50, v51
    v_mfma_f32_32x32x16_bf16 v[144:159], a[8:11], v[248:251], v[144:159]
    buffer_load_dwordx4 a[80:83], v0, s[20:23], s68 offen offset:0 sc1
    v_exp_f32 v52, v52
    v_exp_f32 v53, v53
    v_exp_f32 v54, v54
    v_exp_f32 v55, v55
    v_cvt_pk_bf16_f32 v242, v52, v53
    v_mfma_f32_32x32x16_bf16 v[192:207], a[20:23], a[244:247], v[192:207]
    v_cvt_pk_bf16_f32 v243, v54, v55
    v_exp_f32 v56, v56
    v_exp_f32 v57, v57
    v_exp_f32 v58, v58
    v_exp_f32 v59, v59
    v_cvt_pk_bf16_f32 v244, v56, v57
    v_cvt_pk_bf16_f32 v245, v58, v59
    v_mfma_f32_32x32x16_bf16 v[144:159], a[12:15], v[252:255], v[144:159]
    buffer_load_dwordx4 a[84:87], v186, s[20:23], s68 offen offset:0 sc1
    v_exp_f32 v60, v60
    v_exp_f32 v61, v61
    v_exp_f32 v62, v62
    v_exp_f32 v63, v63
    v_cvt_pk_bf16_f32 v246, v60, v61
    v_cvt_pk_bf16_f32 v247, v62, v63
    v_mfma_f32_32x32x16_bf16 v[48:63], a[16:19], a[248:251], 0
    buffer_load_dwordx4 a[4:7], v2, s[20:23], s66 offen offset:1024 sc1
    v_exp_f32 v192, v192
    v_exp_f32 v193, v193
    v_exp_f32 v194, v194
    v_exp_f32 v195, v195
    v_cvt_pk_bf16_f32 v248, v192, v193
    v_mfma_f32_32x32x16_bf16 v[160:175], a[24:27], v[240:243], v[160:175]
    buffer_load_dwordx4 a[88:91], v0, s[20:23], s68 offen offset:1024 sc1
    v_cvt_pk_bf16_f32 v249, v194, v195
    v_exp_f32 v196, v196
    v_exp_f32 v197, v197
    v_exp_f32 v198, v198
    v_exp_f32 v199, v199
    v_mfma_f32_32x32x16_bf16 v[48:63], a[20:23], a[252:255], v[48:63]
    s_add_u32 s66, s66, 28672
    v_cvt_pk_bf16_f32 v250, v196, v197
    v_cvt_pk_bf16_f32 v251, v198, v199
    v_exp_f32 v200, v200
    v_exp_f32 v201, v201
    v_exp_f32 v202, v202
    v_exp_f32 v203, v203
    v_cvt_pk_bf16_f32 v252, v200, v201
    v_mfma_f32_32x32x16_bf16 v[160:175], a[28:31], v[244:247], v[160:175]
    v_cvt_pk_bf16_f32 v253, v202, v203
    v_exp_f32 v204, v204
    v_exp_f32 v205, v205
    v_exp_f32 v206, v206
    v_exp_f32 v207, v207
    v_cvt_pk_bf16_f32 v254, v204, v205
    v_cvt_pk_bf16_f32 v255, v206, v207
    v_mfma_f32_32x32x16_bf16 v[192:207], a[16:19], a[224:227], 0
    buffer_load_dwordx4 a[8:11], v36, s[20:23], s67 offen offset:0 sc1
    v_exp_f32 v48, v48
    v_exp_f32 v49, v49
    v_exp_f32 v50, v50
    v_exp_f32 v51, v51
    v_cvt_pk_bf16_f32 v240, v48, v49
    v_cvt_pk_bf16_f32 v241, v50, v51
    v_mfma_f32_32x32x16_bf16 v[208:223], a[24:27], v[248:251], v[208:223]
    buffer_load_dwordx4 a[92:95], v186, s[20:23], s68 offen offset:1024 sc1
    v_exp_f32 v52, v52
    v_exp_f32 v53, v53
    v_exp_f32 v54, v54
    v_exp_f32 v55, v55
    v_cvt_pk_bf16_f32 v242, v52, v53
    v_cvt_pk_bf16_f32 v243, v54, v55
    v_mfma_f32_32x32x16_bf16 v[192:207], a[20:23], a[228:231], v[192:207]
    ds_read_b64_tr_b16 v[128:129], v180 offset:0
    ds_read_b64_tr_b16 v[130:131], v180 offset:512
    v_exp_f32 v56, v56
    v_exp_f32 v57, v57
    v_exp_f32 v58, v58
    v_exp_f32 v59, v59
    v_cvt_pk_bf16_f32 v244, v56, v57
    v_cvt_pk_bf16_f32 v245, v58, v59
    v_mfma_f32_32x32x16_bf16 v[208:223], a[28:31], v[252:255], v[208:223]
    buffer_load_dwordx4 a[96:99], v0, s[20:23], s68 offen offset:2048 sc1
    v_exp_f32 v60, v60
    v_exp_f32 v61, v61
    v_exp_f32 v62, v62
    v_exp_f32 v63, v63
    v_cvt_pk_bf16_f32 v246, v60, v61
    v_cvt_pk_bf16_f32 v247, v62, v63
    v_mfma_f32_32x32x16_bf16 v[48:63], a[32:35], a[232:235], 0
    buffer_load_dwordx4 a[12:15], v36, s[20:23], s67 offen offset:1024 sc1
    v_exp_f32 v192, v192
    v_exp_f32 v193, v193
    v_exp_f32 v194, v194
    v_exp_f32 v195, v195
    v_cvt_pk_bf16_f32 v248, v192, v193
    v_cvt_pk_bf16_f32 v249, v194, v195
    v_mfma_f32_32x32x16_bf16 v[224:239], a[24:27], v[240:243], v[224:239]
    buffer_load_dwordx4 a[100:103], v186, s[20:23], s68 offen offset:2048 sc1
    v_exp_f32 v196, v196
    v_exp_f32 v197, v197
    v_exp_f32 v198, v198
    v_exp_f32 v199, v199
    v_cvt_pk_bf16_f32 v250, v196, v197
    v_cvt_pk_bf16_f32 v251, v198, v199
    v_mfma_f32_32x32x16_bf16 v[48:63], a[36:39], a[236:239], v[48:63]
    s_add_u32 s67, s67, 2048
    ds_read_b64_tr_b16 v[132:133], v181 offset:0
    ds_read_b64_tr_b16 v[134:135], v181 offset:512
    v_exp_f32 v200, v200
    v_exp_f32 v201, v201
    v_exp_f32 v202, v202
    v_exp_f32 v203, v203
    v_cvt_pk_bf16_f32 v252, v200, v201
    v_cvt_pk_bf16_f32 v253, v202, v203
    v_mfma_f32_32x32x16_bf16 v[224:239], a[28:31], v[244:247], v[224:239]
    buffer_load_dwordx4 a[104:107], v0, s[20:23], s68 offen offset:3072 sc1
    v_exp_f32 v204, v204
    v_exp_f32 v205, v205
    v_exp_f32 v206, v206
    v_exp_f32 v207, v207
    v_cvt_pk_bf16_f32 v254, v204, v205
    v_cvt_pk_bf16_f32 v255, v206, v207
    v_mfma_f32_32x32x16_bf16 v[192:207], a[32:35], a[240:243], 0
    buffer_load_dwordx4 a[16:19], v2, s[20:23], s66 offen offset:0 sc1
    v_exp_f32 v48, v48
    v_exp_f32 v49, v49
    v_exp_f32 v50, v50
    v_mfma_f32_32x32x16_bf16 v[144:159], a[24:27], v[248:251], v[144:159]
    buffer_load_dwordx4 a[108:111], v186, s[20:23], s68 offen offset:3072 sc1
    v_exp_f32 v51, v51
    v_cvt_pk_bf16_f32 v240, v48, v49
    v_cvt_pk_bf16_f32 v241, v50, v51
    v_exp_f32 v52, v52
    s_waitcnt vmcnt(10) lgkmcnt(0)
    v_mfma_f32_32x32x16_bf16 v[64:79], v[128:131], a[80:83], 0
    s_add_u32 s68, s68, 4096
    ds_read_b64_tr_b16 v[136:137], v180 offset:2048
    v_exp_f32 v53, v53
    v_exp_f32 v54, v54
    v_exp_f32 v55, v55
    v_cvt_pk_bf16_f32 v242, v52, v53
    v_cvt_pk_bf16_f32 v243, v54, v55
    v_mfma_f32_32x32x16_bf16 v[192:207], a[36:39], a[244:247], v[192:207]
    s_cmp_eq_u32 s68, s78
    v_exp_f32 v56, v56
    v_exp_f32 v57, v57
    v_exp_f32 v58, v58
    v_exp_f32 v59, v59
    v_mfma_f32_32x32x16_bf16 v[144:159], a[28:31], v[252:255], v[144:159]
    s_cselect_b32 s68, s77, s68
    buffer_load_dwordx4 a[112:115], v0, s[20:23], s68 offen offset:0 sc1
    v_cvt_pk_bf16_f32 v244, v56, v57
    v_cvt_pk_bf16_f32 v245, v58, v59
    v_exp_f32 v60, v60
    v_exp_f32 v61, v61
    v_mfma_f32_32x32x16_bf16 v[80:95], v[132:135], a[80:83], 0
    ds_read_b64_tr_b16 v[138:139], v180 offset:2560
    ds_read_b64_tr_b16 v[140:141], v181 offset:2048
    v_exp_f32 v62, v62
    v_exp_f32 v63, v63
    v_cvt_pk_bf16_f32 v246, v60, v61
    v_cvt_pk_bf16_f32 v247, v62, v63
    v_mfma_f32_32x32x16_bf16 v[48:63], a[32:35], a[248:251], 0
    buffer_load_dwordx4 a[20:23], v2, s[20:23], s66 offen offset:1024 sc1
    v_exp_f32 v192, v192
    v_exp_f32 v193, v193
    v_exp_f32 v194, v194
    v_mfma_f32_32x32x16_bf16 v[160:175], a[40:43], v[240:243], v[160:175]
    buffer_load_dwordx4 a[116:119], v186, s[20:23], s68 offen offset:0 sc1
    v_exp_f32 v195, v195
    v_cvt_pk_bf16_f32 v248, v192, v193
    v_cvt_pk_bf16_f32 v249, v194, v195
    v_exp_f32 v196, v196
    v_mfma_f32_32x32x16_bf16 v[96:111], v[128:131], a[84:87], 0
    s_add_u32 s66, s66, 28672
    ds_read_b64_tr_b16 v[142:143], v181 offset:2560
    v_exp_f32 v197, v197
    v_exp_f32 v198, v198
    v_exp_f32 v199, v199
    v_mfma_f32_32x32x16_bf16 v[48:63], a[36:39], a[252:255], v[48:63]
    v_cvt_pk_bf16_f32 v250, v196, v197
    v_cvt_pk_bf16_f32 v251, v198, v199
    v_exp_f32 v200, v200
    v_exp_f32 v201, v201
    v_exp_f32 v202, v202
    v_mfma_f32_32x32x16_bf16 v[160:175], a[44:47], v[244:247], v[160:175]
    v_exp_f32 v203, v203
    v_cvt_pk_bf16_f32 v252, v200, v201
    v_cvt_pk_bf16_f32 v253, v202, v203
    v_exp_f32 v204, v204
    v_mfma_f32_32x32x16_bf16 v[112:127], v[132:135], a[84:87], 0
    s_waitcnt vmcnt(9) lgkmcnt(0)
    v_exp_f32 v205, v205
    v_exp_f32 v206, v206
    v_exp_f32 v207, v207
    v_cvt_pk_bf16_f32 v254, v204, v205
    v_cvt_pk_bf16_f32 v255, v206, v207
    v_mfma_f32_32x32x16_bf16 v[192:207], a[32:35], a[224:227], 0
    buffer_load_dwordx4 a[24:27], v36, s[20:23], s67 offen offset:0 sc1
    v_exp_f32 v48, v48
    v_exp_f32 v49, v49
    v_exp_f32 v50, v50
    v_mfma_f32_32x32x16_bf16 v[208:223], a[40:43], v[248:251], v[208:223]
    buffer_store_dwordx4 v[14:17], v2, s[20:23], s81 offen offset:0 sc1
    v_exp_f32 v51, v51
    v_cvt_pk_bf16_f32 v240, v48, v49
    v_cvt_pk_bf16_f32 v241, v50, v51
    v_exp_f32 v52, v52
    v_mfma_f32_32x32x16_bf16 v[64:79], v[136:139], a[88:91], v[64:79]
    ds_read_b64_tr_b16 v[128:129], v180 offset:4096
    v_exp_f32 v53, v53
    v_exp_f32 v54, v54
    v_exp_f32 v55, v55
    v_cvt_pk_bf16_f32 v242, v52, v53
    v_cvt_pk_bf16_f32 v243, v54, v55
    v_mfma_f32_32x32x16_bf16 v[192:207], a[36:39], a[228:231], v[192:207]
    v_exp_f32 v56, v56
    v_exp_f32 v57, v57
    v_exp_f32 v58, v58
    v_exp_f32 v59, v59
    v_mfma_f32_32x32x16_bf16 v[208:223], a[44:47], v[252:255], v[208:223]
    buffer_load_dwordx4 a[120:123], v0, s[20:23], s68 offen offset:1024 sc1
    v_cvt_pk_bf16_f32 v244, v56, v57
    v_cvt_pk_bf16_f32 v245, v58, v59
    v_exp_f32 v60, v60
    v_exp_f32 v61, v61
    v_mfma_f32_32x32x16_bf16 v[80:95], v[140:143], a[88:91], v[80:95]
    ds_read_b64_tr_b16 v[130:131], v180 offset:4608
    ds_read_b64_tr_b16 v[132:133], v181 offset:4096
    v_exp_f32 v62, v62
    v_exp_f32 v63, v63
    v_cvt_pk_bf16_f32 v246, v60, v61
    v_cvt_pk_bf16_f32 v247, v62, v63
    v_mfma_f32_32x32x16_bf16 v[48:63], a[48:51], a[232:235], 0
    buffer_load_dwordx4 a[28:31], v36, s[20:23], s67 offen offset:1024 sc1
    v_exp_f32 v192, v192
    v_exp_f32 v193, v193
    v_exp_f32 v194, v194
    v_mfma_f32_32x32x16_bf16 v[224:239], a[40:43], v[240:243], v[224:239]
    buffer_store_dwordx4 v[14:17], v2, s[20:23], s81 offen offset:1024 sc1
    v_exp_f32 v195, v195
    v_cvt_pk_bf16_f32 v248, v192, v193
    v_cvt_pk_bf16_f32 v249, v194, v195
    v_exp_f32 v196, v196
    v_mfma_f32_32x32x16_bf16 v[96:111], v[136:139], a[92:95], v[96:111]
    s_add_u32 s67, s67, 2048
    ds_read_b64_tr_b16 v[134:135], v181 offset:4608
    v_exp_f32 v197, v197
    v_exp_f32 v198, v198
    v_exp_f32 v199, v199
    v_cvt_pk_bf16_f32 v250, v196, v197
    v_mfma_f32_32x32x16_bf16 v[48:63], a[52:55], a[236:239], v[48:63]
    s_cmp_eq_u32 s67, s76
    v_cvt_pk_bf16_f32 v251, v198, v199
    v_exp_f32 v200, v200
    v_exp_f32 v201, v201
    v_exp_f32 v202, v202
    v_mfma_f32_32x32x16_bf16 v[224:239], a[44:47], v[244:247], v[224:239]
    buffer_load_dwordx4 a[124:127], v186, s[20:23], s68 offen offset:1024 sc1
    v_exp_f32 v203, v203
    v_cvt_pk_bf16_f32 v252, v200, v201
    v_cvt_pk_bf16_f32 v253, v202, v203
    v_exp_f32 v204, v204
    v_mfma_f32_32x32x16_bf16 v[112:127], v[140:143], a[92:95], v[112:127]
    s_waitcnt vmcnt(12) lgkmcnt(0)
    v_exp_f32 v205, v205
    v_exp_f32 v206, v206
    v_exp_f32 v207, v207
    v_cvt_pk_bf16_f32 v254, v204, v205
    v_cvt_pk_bf16_f32 v255, v206, v207
    v_mfma_f32_32x32x16_bf16 v[192:207], a[48:51], a[240:243], 0
    s_cselect_b32 s66, s74, s66
    buffer_load_dwordx4 a[32:35], v2, s[20:23], s66 offen offset:0 sc1
    v_exp_f32 v48, v48
    v_exp_f32 v49, v49
    v_exp_f32 v50, v50
    v_mfma_f32_32x32x16_bf16 v[144:159], a[40:43], v[248:251], v[144:159]
    buffer_load_dwordx4 a[128:131], v0, s[20:23], s68 offen offset:2048 sc1
    v_exp_f32 v51, v51
    v_cvt_pk_bf16_f32 v240, v48, v49
    v_cvt_pk_bf16_f32 v241, v50, v51
    v_exp_f32 v52, v52
    v_mfma_f32_32x32x16_bf16 v[64:79], v[128:131], a[96:99], v[64:79]
    s_cselect_b32 s67, s75, s67
    ds_read_b64_tr_b16 v[136:137], v180 offset:6144
    v_exp_f32 v53, v53
    v_exp_f32 v54, v54
    v_exp_f32 v55, v55
    v_cvt_pk_bf16_f32 v242, v52, v53
    v_cvt_pk_bf16_f32 v243, v54, v55
    v_mfma_f32_32x32x16_bf16 v[192:207], a[52:55], a[244:247], v[192:207]
    v_exp_f32 v56, v56
    v_exp_f32 v57, v57
    v_exp_f32 v58, v58
    v_exp_f32 v59, v59
    v_mfma_f32_32x32x16_bf16 v[144:159], a[44:47], v[252:255], v[144:159]
    buffer_load_dwordx4 a[132:135], v186, s[20:23], s68 offen offset:2048 sc1
    v_cvt_pk_bf16_f32 v244, v56, v57
    v_cvt_pk_bf16_f32 v245, v58, v59
    v_exp_f32 v60, v60
    v_exp_f32 v61, v61
    v_mfma_f32_32x32x16_bf16 v[80:95], v[132:135], a[96:99], v[80:95]
    ds_read_b64_tr_b16 v[138:139], v180 offset:6656
    ds_read_b64_tr_b16 v[140:141], v181 offset:6144
    v_exp_f32 v62, v62
    v_exp_f32 v63, v63
    v_cvt_pk_bf16_f32 v246, v60, v61
    v_cvt_pk_bf16_f32 v247, v62, v63
    v_mfma_f32_32x32x16_bf16 v[48:63], a[48:51], a[248:251], 0
    buffer_load_dwordx4 a[36:39], v2, s[20:23], s66 offen offset:1024 sc1
    v_exp_f32 v192, v192
    v_exp_f32 v193, v193
    v_exp_f32 v194, v194
    v_mfma_f32_32x32x16_bf16 v[160:175], a[56:59], v[240:243], v[160:175]
    buffer_load_dwordx4 a[136:139], v0, s[20:23], s68 offen offset:3072 sc1
    v_exp_f32 v195, v195
    v_cvt_pk_bf16_f32 v248, v192, v193
    v_cvt_pk_bf16_f32 v249, v194, v195
    v_exp_f32 v196, v196
    v_mfma_f32_32x32x16_bf16 v[96:111], v[128:131], a[100:103], v[96:111]
    s_add_u32 s66, s66, 28672
    ds_read_b64_tr_b16 v[142:143], v181 offset:6656
    v_exp_f32 v197, v197
    v_exp_f32 v198, v198
    v_exp_f32 v199, v199
    v_mfma_f32_32x32x16_bf16 v[48:63], a[52:55], a[252:255], v[48:63]
    v_cvt_pk_bf16_f32 v250, v196, v197
    v_cvt_pk_bf16_f32 v251, v198, v199
    v_exp_f32 v200, v200
    v_exp_f32 v201, v201
    v_exp_f32 v202, v202
    v_mfma_f32_32x32x16_bf16 v[160:175], a[60:63], v[244:247], v[160:175]
    v_exp_f32 v203, v203
    v_cvt_pk_bf16_f32 v252, v200, v201
    v_cvt_pk_bf16_f32 v253, v202, v203
    v_exp_f32 v204, v204
    v_mfma_f32_32x32x16_bf16 v[112:127], v[132:135], a[100:103], v[112:127]
    s_waitcnt vmcnt(14) lgkmcnt(0)
    v_exp_f32 v205, v205
    v_exp_f32 v206, v206
    v_exp_f32 v207, v207
    v_cvt_pk_bf16_f32 v254, v204, v205
    v_cvt_pk_bf16_f32 v255, v206, v207
    v_mfma_f32_32x32x16_bf16 v[192:207], a[48:51], a[224:227], 0
    buffer_load_dwordx4 a[40:43], v36, s[20:23], s67 offen offset:0 sc1
    v_exp_f32 v48, v48
    v_exp_f32 v49, v49
    v_exp_f32 v50, v50
    v_mfma_f32_32x32x16_bf16 v[208:223], a[56:59], v[248:251], v[208:223]
    buffer_load_dwordx4 a[140:143], v186, s[20:23], s68 offen offset:3072 sc1
    v_exp_f32 v51, v51
    v_cvt_pk_bf16_f32 v240, v48, v49
    v_cvt_pk_bf16_f32 v241, v50, v51
    v_exp_f32 v52, v52
    v_mfma_f32_32x32x16_bf16 v[64:79], v[136:139], a[104:107], v[64:79]
    s_add_u32 s68, s68, 4096
    ds_read_b64_tr_b16 v[128:129], v180 offset:8192
    v_exp_f32 v53, v53
    v_exp_f32 v54, v54
    v_exp_f32 v55, v55
    v_cvt_pk_bf16_f32 v242, v52, v53
    v_cvt_pk_bf16_f32 v243, v54, v55
    v_mfma_f32_32x32x16_bf16 v[192:207], a[52:55], a[228:231], v[192:207]
    s_cmp_eq_u32 s68, s78
    v_exp_f32 v56, v56
    v_exp_f32 v57, v57
    v_exp_f32 v58, v58
    v_exp_f32 v59, v59
    v_mfma_f32_32x32x16_bf16 v[208:223], a[60:63], v[252:255], v[208:223]
    s_cselect_b32 s68, s77, s68
    s_lshl_b32 s52, s85, 7
    s_add_u32 s52, s52, 0x4000
    buffer_load_dword v32, v40, s[20:23], s52 offen sc1
    v_cvt_pk_bf16_f32 v244, v56, v57
    v_cvt_pk_bf16_f32 v245, v58, v59
    v_exp_f32 v60, v60
    v_exp_f32 v61, v61
    v_mfma_f32_32x32x16_bf16 v[80:95], v[140:143], a[104:107], v[80:95]
    ds_read_b64_tr_b16 v[130:131], v180 offset:8704
    ds_read_b64_tr_b16 v[132:133], v181 offset:8192
    v_exp_f32 v62, v62
    v_exp_f32 v63, v63
    v_cvt_pk_bf16_f32 v246, v60, v61
    v_cvt_pk_bf16_f32 v247, v62, v63
    v_mfma_f32_32x32x16_bf16 v[48:63], a[64:67], a[232:235], 0
    buffer_load_dwordx4 a[44:47], v36, s[20:23], s67 offen offset:1024 sc1
    v_exp_f32 v192, v192
    v_exp_f32 v193, v193
    v_exp_f32 v194, v194
    v_mfma_f32_32x32x16_bf16 v[224:239], a[56:59], v[240:243], v[224:239]
    buffer_load_dwordx4 a[144:147], v0, s[20:23], s68 offen offset:0 sc1
    v_exp_f32 v195, v195
    v_cvt_pk_bf16_f32 v248, v192, v193
    v_cvt_pk_bf16_f32 v249, v194, v195
    v_exp_f32 v196, v196
    v_mfma_f32_32x32x16_bf16 v[96:111], v[136:139], a[108:111], v[96:111]
    s_add_u32 s67, s67, 2048
    ds_read_b64_tr_b16 v[134:135], v181 offset:8704
    v_exp_f32 v197, v197
    v_exp_f32 v198, v198
    v_exp_f32 v199, v199
    v_cvt_pk_bf16_f32 v250, v196, v197
    v_mfma_f32_32x32x16_bf16 v[48:63], a[68:71], a[236:239], v[48:63]
    v_cvt_pk_bf16_f32 v251, v198, v199
    v_exp_f32 v200, v200
    v_exp_f32 v201, v201
    v_exp_f32 v202, v202
    v_mfma_f32_32x32x16_bf16 v[224:239], a[60:63], v[244:247], v[224:239]
    buffer_load_dwordx4 a[148:151], v186, s[20:23], s68 offen offset:0 sc1
    v_exp_f32 v203, v203
    v_cvt_pk_bf16_f32 v252, v200, v201
    v_cvt_pk_bf16_f32 v253, v202, v203
    v_exp_f32 v204, v204
    v_mfma_f32_32x32x16_bf16 v[112:127], v[140:143], a[108:111], v[112:127]
    s_waitcnt vmcnt(17) lgkmcnt(0)
    v_exp_f32 v205, v205
    v_exp_f32 v206, v206
    v_exp_f32 v207, v207
    v_cvt_pk_bf16_f32 v254, v204, v205
    v_cvt_pk_bf16_f32 v255, v206, v207
    v_mfma_f32_32x32x16_bf16 v[192:207], a[64:67], a[240:243], 0
    buffer_load_dwordx4 a[48:51], v2, s[20:23], s66 offen offset:0 sc1
    v_exp_f32 v48, v48
    v_exp_f32 v49, v49
    v_exp_f32 v50, v50
    v_mfma_f32_32x32x16_bf16 v[144:159], a[56:59], v[248:251], v[144:159]
    buffer_load_dwordx4 a[152:155], v0, s[20:23], s68 offen offset:1024 sc1
    v_exp_f32 v51, v51
    v_cvt_pk_bf16_f32 v240, v48, v49
    v_cvt_pk_bf16_f32 v241, v50, v51
    v_exp_f32 v52, v52
    v_mfma_f32_32x32x16_bf16 v[64:79], v[128:131], a[112:115], v[64:79]
    ds_read_b64_tr_b16 v[136:137], v180 offset:10240
    v_exp_f32 v53, v53
    v_exp_f32 v54, v54
    v_exp_f32 v55, v55
    v_cvt_pk_bf16_f32 v242, v52, v53
    v_cvt_pk_bf16_f32 v243, v54, v55
    v_mfma_f32_32x32x16_bf16 v[192:207], a[68:71], a[244:247], v[192:207]
    v_exp_f32 v56, v56
    v_exp_f32 v57, v57
    v_exp_f32 v58, v58
    v_exp_f32 v59, v59
    v_mfma_f32_32x32x16_bf16 v[144:159], a[60:63], v[252:255], v[144:159]
    buffer_load_dwordx4 a[156:159], v186, s[20:23], s68 offen offset:1024 sc1
    v_cvt_pk_bf16_f32 v244, v56, v57
    v_cvt_pk_bf16_f32 v245, v58, v59
    v_exp_f32 v60, v60
    v_exp_f32 v61, v61
    v_mfma_f32_32x32x16_bf16 v[80:95], v[132:135], a[112:115], v[80:95]
    ds_read_b64_tr_b16 v[138:139], v180 offset:10752
    ds_read_b64_tr_b16 v[140:141], v181 offset:10240
    v_exp_f32 v62, v62
    v_exp_f32 v63, v63
    v_cvt_pk_bf16_f32 v246, v60, v61
    v_cvt_pk_bf16_f32 v247, v62, v63
    v_mfma_f32_32x32x16_bf16 v[48:63], a[64:67], a[248:251], 0
    buffer_load_dwordx4 a[52:55], v2, s[20:23], s66 offen offset:1024 sc1
    v_exp_f32 v192, v192
    v_exp_f32 v193, v193
    v_exp_f32 v194, v194
    v_mfma_f32_32x32x16_bf16 v[160:175], a[72:75], v[240:243], v[160:175]
    buffer_load_dwordx4 a[160:163], v0, s[20:23], s68 offen offset:2048 sc1
    v_exp_f32 v195, v195
    v_cvt_pk_bf16_f32 v248, v192, v193
    v_cvt_pk_bf16_f32 v249, v194, v195
    v_exp_f32 v196, v196
    v_mfma_f32_32x32x16_bf16 v[96:111], v[128:131], a[116:119], v[96:111]
    s_add_u32 s66, s66, 28672
    ds_read_b64_tr_b16 v[142:143], v181 offset:10752
    v_exp_f32 v197, v197
    v_exp_f32 v198, v198
    v_exp_f32 v199, v199
    v_mfma_f32_32x32x16_bf16 v[48:63], a[68:71], a[252:255], v[48:63]
    v_cvt_pk_bf16_f32 v250, v196, v197
    v_cvt_pk_bf16_f32 v251, v198, v199
    v_exp_f32 v200, v200
    v_exp_f32 v201, v201
    v_exp_f32 v202, v202
    v_mfma_f32_32x32x16_bf16 v[160:175], a[76:79], v[244:247], v[160:175]
    v_exp_f32 v203, v203
    v_cvt_pk_bf16_f32 v252, v200, v201
    v_cvt_pk_bf16_f32 v253, v202, v203
    v_exp_f32 v204, v204
    v_mfma_f32_32x32x16_bf16 v[112:127], v[132:135], a[116:119], v[112:127]
    s_waitcnt vmcnt(16) lgkmcnt(0)
    v_exp_f32 v205, v205
    v_exp_f32 v206, v206
    v_exp_f32 v207, v207
    v_cvt_pk_bf16_f32 v254, v204, v205
    v_cvt_pk_bf16_f32 v255, v206, v207
    v_mfma_f32_32x32x16_bf16 v[192:207], a[64:67], a[224:227], 0
    buffer_load_dwordx4 a[56:59], v36, s[20:23], s67 offen offset:0 sc1
    v_exp_f32 v48, v48
    v_exp_f32 v49, v49
    v_exp_f32 v50, v50
    v_mfma_f32_32x32x16_bf16 v[208:223], a[72:75], v[248:251], v[208:223]
    buffer_load_dwordx4 a[164:167], v186, s[20:23], s68 offen offset:2048 sc1
    v_exp_f32 v51, v51
    v_cvt_pk_bf16_f32 v240, v48, v49
    v_cvt_pk_bf16_f32 v241, v50, v51
    v_exp_f32 v52, v52
    v_mfma_f32_32x32x16_bf16 v[64:79], v[136:139], a[120:123], v[64:79]
    ds_read_b64_tr_b16 v[128:129], v180 offset:12288
    v_exp_f32 v53, v53
    v_exp_f32 v54, v54
    v_exp_f32 v55, v55
    v_cvt_pk_bf16_f32 v242, v52, v53
    v_cvt_pk_bf16_f32 v243, v54, v55
    v_mfma_f32_32x32x16_bf16 v[192:207], a[68:71], a[228:231], v[192:207]
    v_exp_f32 v56, v56
    v_exp_f32 v57, v57
    v_exp_f32 v58, v58
    v_exp_f32 v59, v59
    v_mfma_f32_32x32x16_bf16 v[208:223], a[76:79], v[252:255], v[208:223]
    buffer_load_dwordx4 a[168:171], v0, s[20:23], s68 offen offset:3072 sc1
    v_cvt_pk_bf16_f32 v244, v56, v57
    v_cvt_pk_bf16_f32 v245, v58, v59
    v_exp_f32 v60, v60
    v_exp_f32 v61, v61
    v_mfma_f32_32x32x16_bf16 v[80:95], v[140:143], a[120:123], v[80:95]
    ds_read_b64_tr_b16 v[130:131], v180 offset:12800
    ds_read_b64_tr_b16 v[132:133], v181 offset:12288
    v_exp_f32 v62, v62
    v_exp_f32 v63, v63
    v_cvt_pk_bf16_f32 v246, v60, v61
    v_cvt_pk_bf16_f32 v247, v62, v63
    v_mfma_f32_32x32x16_bf16 v[48:63], a[0:3], a[232:235], 0
    buffer_load_dwordx4 a[60:63], v36, s[20:23], s67 offen offset:1024 sc1
    v_exp_f32 v192, v192
    v_exp_f32 v193, v193
    v_exp_f32 v194, v194
    v_mfma_f32_32x32x16_bf16 v[224:239], a[72:75], v[240:243], v[224:239]
    buffer_load_dwordx4 a[172:175], v186, s[20:23], s68 offen offset:3072 sc1
    v_exp_f32 v195, v195
    v_cvt_pk_bf16_f32 v248, v192, v193
    v_cvt_pk_bf16_f32 v249, v194, v195
    v_exp_f32 v196, v196
    v_mfma_f32_32x32x16_bf16 v[96:111], v[136:139], a[124:127], v[96:111]
    s_add_u32 s67, s67, 2048
    ds_read_b64_tr_b16 v[134:135], v181 offset:12800
    v_exp_f32 v197, v197
    v_exp_f32 v198, v198
    v_exp_f32 v199, v199
    v_cvt_pk_bf16_f32 v250, v196, v197
    v_mfma_f32_32x32x16_bf16 v[48:63], a[4:7], a[236:239], v[48:63]
    s_cmp_eq_u32 s67, s76
    v_cvt_pk_bf16_f32 v251, v198, v199
    v_exp_f32 v200, v200
    v_exp_f32 v201, v201
    v_exp_f32 v202, v202
    v_mfma_f32_32x32x16_bf16 v[224:239], a[76:79], v[244:247], v[224:239]
    s_cselect_b32 s66, s74, s66
    s_cselect_b32 s67, s75, s67
    s_add_u32 s68, s68, 4096
    s_cmp_eq_u32 s68, s78
    s_cselect_b32 s68, s77, s68
    s_add_u32 m0, s71, 0
    s_nop 0
    buffer_load_dwordx4 v176, s[28:31], s70 offen offset:0  lds
    v_exp_f32 v203, v203
    v_cvt_pk_bf16_f32 v252, v200, v201
    v_cvt_pk_bf16_f32 v253, v202, v203
    v_exp_f32 v204, v204
    v_mfma_f32_32x32x16_bf16 v[112:127], v[140:143], a[124:127], v[112:127]
    s_waitcnt vmcnt(19) lgkmcnt(0)
    v_exp_f32 v205, v205
    v_exp_f32 v206, v206
    v_exp_f32 v207, v207
    v_cvt_pk_bf16_f32 v254, v204, v205
    v_cvt_pk_bf16_f32 v255, v206, v207
    v_mfma_f32_32x32x16_bf16 v[192:207], a[0:3], a[240:243], 0
    buffer_load_dwordx4 a[64:67], v2, s[20:23], s66 offen offset:0 sc1
    v_exp_f32 v48, v48
    v_exp_f32 v49, v49
    v_exp_f32 v50, v50
    v_mfma_f32_32x32x16_bf16 v[144:159], a[72:75], v[248:251], v[144:159]
    buffer_store_dword v3, off, s[20:23], s48 sc1
    v_exp_f32 v51, v51
    v_cvt_pk_bf16_f32 v240, v48, v49
    v_cvt_pk_bf16_f32 v241, v50, v51
    v_exp_f32 v52, v52
    v_mfma_f32_32x32x16_bf16 v[64:79], v[128:131], a[128:131], v[64:79]
    ds_read_b64_tr_b16 v[136:137], v180 offset:14336
    v_exp_f32 v53, v53
    v_exp_f32 v54, v54
    v_exp_f32 v55, v55
    v_cvt_pk_bf16_f32 v242, v52, v53
    v_cvt_pk_bf16_f32 v243, v54, v55
    v_mfma_f32_32x32x16_bf16 v[192:207], a[4:7], a[244:247], v[192:207]
    v_exp_f32 v56, v56
    v_exp_f32 v57, v57
    v_exp_f32 v58, v58
    v_exp_f32 v59, v59
    v_mfma_f32_32x32x16_bf16 v[144:159], a[76:79], v[252:255], v[144:159]
    buffer_load_dwordx4 v177, s[28:31], s70 offen offset:1024  lds
    v_cvt_pk_bf16_f32 v244, v56, v57
    v_cvt_pk_bf16_f32 v245, v58, v59
    v_exp_f32 v60, v60
    v_exp_f32 v61, v61
    v_mfma_f32_32x32x16_bf16 v[80:95], v[132:135], a[128:131], v[80:95]
    ds_read_b64_tr_b16 v[138:139], v180 offset:14848
    ds_read_b64_tr_b16 v[140:141], v181 offset:14336
    v_exp_f32 v62, v62
    v_exp_f32 v63, v63
    v_cvt_pk_bf16_f32 v246, v60, v61
    v_cvt_pk_bf16_f32 v247, v62, v63
    v_mfma_f32_32x32x16_bf16 v[48:63], a[0:3], a[248:251], 0
    buffer_load_dwordx4 a[68:71], v2, s[20:23], s66 offen offset:1024 sc1
    v_exp_f32 v192, v192
    v_exp_f32 v193, v193
    v_exp_f32 v194, v194
    v_mfma_f32_32x32x16_bf16 v[160:175], a[8:11], v[240:243], v[160:175]
    buffer_load_dwordx4 v178, s[28:31], s70 offen offset:2048  lds
    v_exp_f32 v195, v195
    v_cvt_pk_bf16_f32 v248, v192, v193
    v_cvt_pk_bf16_f32 v249, v194, v195
    v_exp_f32 v196, v196
    v_mfma_f32_32x32x16_bf16 v[96:111], v[128:131], a[132:135], v[96:111]
    s_add_u32 s66, s66, 28672
    ds_read_b64_tr_b16 v[142:143], v181 offset:14848
    v_exp_f32 v197, v197
    v_exp_f32 v198, v198
    v_exp_f32 v199, v199
    v_mfma_f32_32x32x16_bf16 v[48:63], a[4:7], a[252:255], v[48:63]
    v_cvt_pk_bf16_f32 v250, v196, v197
    v_cvt_pk_bf16_f32 v251, v198, v199
    v_exp_f32 v200, v200
    v_exp_f32 v201, v201
    v_exp_f32 v202, v202
    v_mfma_f32_32x32x16_bf16 v[160:175], a[12:15], v[244:247], v[160:175]
    v_exp_f32 v203, v203
    v_cvt_pk_bf16_f32 v252, v200, v201
    v_cvt_pk_bf16_f32 v253, v202, v203
    v_exp_f32 v204, v204
    v_mfma_f32_32x32x16_bf16 v[112:127], v[132:135], a[132:135], v[112:127]
    s_waitcnt vmcnt(20) lgkmcnt(0)
    v_exp_f32 v205, v205
    v_exp_f32 v206, v206
    v_exp_f32 v207, v207
    v_cvt_pk_bf16_f32 v254, v204, v205
    v_cvt_pk_bf16_f32 v255, v206, v207
    v_mfma_f32_32x32x16_bf16 v[192:207], a[0:3], a[224:227], 0
    buffer_load_dwordx4 a[72:75], v36, s[20:23], s67 offen offset:0 sc1
    v_exp_f32 v48, v48
    v_exp_f32 v49, v49
    v_exp_f32 v50, v50
    v_mfma_f32_32x32x16_bf16 v[208:223], a[8:11], v[248:251], v[208:223]
    buffer_load_dwordx4 v179, s[28:31], s70 offen offset:3072  lds
    v_exp_f32 v51, v51
    v_cvt_pk_bf16_f32 v240, v48, v49
    v_cvt_pk_bf16_f32 v241, v50, v51
    v_exp_f32 v52, v52
    v_mfma_f32_32x32x16_bf16 v[64:79], v[136:139], a[136:139], v[64:79]
    s_add_u32 s70, s70, 28672
    ds_read_b64_tr_b16 v[128:129], v182 offset:0
    v_exp_f32 v53, v53
    v_exp_f32 v54, v54
    v_exp_f32 v55, v55
    v_cvt_pk_bf16_f32 v242, v52, v53
    v_cvt_pk_bf16_f32 v243, v54, v55
    v_mfma_f32_32x32x16_bf16 v[192:207], a[4:7], a[228:231], v[192:207]
    v_exp_f32 v56, v56
    v_exp_f32 v57, v57
    v_exp_f32 v58, v58
    v_exp_f32 v59, v59
    v_mfma_f32_32x32x16_bf16 v[208:223], a[12:15], v[252:255], v[208:223]
    buffer_load_dwordx4 a[176:179], v0, s[20:23], s68 offen offset:0 sc1
    v_cvt_pk_bf16_f32 v244, v56, v57
    v_cvt_pk_bf16_f32 v245, v58, v59
    v_exp_f32 v60, v60
    v_exp_f32 v61, v61
    v_mfma_f32_32x32x16_bf16 v[80:95], v[140:143], a[136:139], v[80:95]
    ds_read_b64_tr_b16 v[130:131], v182 offset:512
    ds_read_b64_tr_b16 v[132:133], v183 offset:0
    v_exp_f32 v62, v62
    v_exp_f32 v63, v63
    v_cvt_pk_bf16_f32 v246, v60, v61
    v_cvt_pk_bf16_f32 v247, v62, v63
    v_mfma_f32_32x32x16_bf16 v[48:63], a[16:19], a[232:235], 0
    buffer_load_dwordx4 a[76:79], v36, s[20:23], s67 offen offset:1024 sc1
    v_exp_f32 v192, v192
    v_exp_f32 v193, v193
    v_exp_f32 v194, v194
    v_mfma_f32_32x32x16_bf16 v[224:239], a[8:11], v[240:243], v[224:239]
    buffer_load_dwordx4 a[180:183], v186, s[20:23], s68 offen offset:0 sc1
    v_exp_f32 v195, v195
    v_cvt_pk_bf16_f32 v248, v192, v193
    v_cvt_pk_bf16_f32 v249, v194, v195
    v_exp_f32 v196, v196
    v_mfma_f32_32x32x16_bf16 v[96:111], v[136:139], a[140:143], v[96:111]
    s_add_u32 s67, s67, 2048
    ds_read_b64_tr_b16 v[134:135], v183 offset:512
    v_exp_f32 v197, v197
    v_exp_f32 v198, v198
    v_exp_f32 v199, v199
    v_cvt_pk_bf16_f32 v250, v196, v197
    v_mfma_f32_32x32x16_bf16 v[48:63], a[20:23], a[236:239], v[48:63]
    v_cvt_pk_bf16_f32 v251, v198, v199
    v_exp_f32 v200, v200
    v_exp_f32 v201, v201
    v_exp_f32 v202, v202
    v_mfma_f32_32x32x16_bf16 v[224:239], a[12:15], v[244:247], v[224:239]
    buffer_load_dwordx4 a[184:187], v0, s[20:23], s68 offen offset:1024 sc1
    v_exp_f32 v203, v203
    v_cvt_pk_bf16_f32 v252, v200, v201
    v_cvt_pk_bf16_f32 v253, v202, v203
    v_exp_f32 v204, v204
    v_mfma_f32_32x32x16_bf16 v[112:127], v[140:143], a[140:143], v[112:127]
    s_waitcnt vmcnt(22) lgkmcnt(0)
    v_exp_f32 v205, v205
    v_exp_f32 v206, v206
    v_exp_f32 v207, v207
    v_cvt_pk_bf16_f32 v254, v204, v205
    v_cvt_pk_bf16_f32 v255, v206, v207
    v_mfma_f32_32x32x16_bf16 v[192:207], a[16:19], a[240:243], 0
    buffer_load_dwordx4 a[0:3], v2, s[20:23], s66 offen offset:0 sc1
    v_exp_f32 v48, v48
    v_exp_f32 v49, v49
    v_exp_f32 v50, v50
    v_mfma_f32_32x32x16_bf16 v[144:159], a[8:11], v[248:251], v[144:159]
    buffer_load_dwordx4 a[188:191], v186, s[20:23], s68 offen offset:1024 sc1
    v_exp_f32 v51, v51
    v_cvt_pk_bf16_f32 v240, v48, v49
    v_cvt_pk_bf16_f32 v241, v50, v51
    v_exp_f32 v52, v52
    v_mfma_f32_32x32x16_bf16 v[64:79], v[128:131], a[144:147], v[64:79]
    s_add_u32 m0, s71, 4096
    ds_read_b64_tr_b16 v[136:137], v182 offset:2048
    v_exp_f32 v53, v53
    v_exp_f32 v54, v54
    v_exp_f32 v55, v55
    v_cvt_pk_bf16_f32 v242, v52, v53
    v_cvt_pk_bf16_f32 v243, v54, v55
    v_mfma_f32_32x32x16_bf16 v[192:207], a[20:23], a[244:247], v[192:207]
    v_exp_f32 v56, v56
    v_exp_f32 v57, v57
    v_exp_f32 v58, v58
    v_exp_f32 v59, v59
    v_mfma_f32_32x32x16_bf16 v[144:159], a[12:15], v[252:255], v[144:159]
    buffer_load_dwordx4 v176, s[28:31], s70 offen offset:0  lds
    v_cvt_pk_bf16_f32 v244, v56, v57
    v_cvt_pk_bf16_f32 v245, v58, v59
    v_exp_f32 v60, v60
    v_exp_f32 v61, v61
    v_mfma_f32_32x32x16_bf16 v[80:95], v[132:135], a[144:147], v[80:95]
    ds_read_b64_tr_b16 v[138:139], v182 offset:2560
    ds_read_b64_tr_b16 v[140:141], v183 offset:2048
    v_exp_f32 v62, v62
    v_exp_f32 v63, v63
    v_cvt_pk_bf16_f32 v246, v60, v61
    v_cvt_pk_bf16_f32 v247, v62, v63
    v_mfma_f32_32x32x16_bf16 v[48:63], a[16:19], a[248:251], 0
    buffer_load_dwordx4 a[4:7], v2, s[20:23], s66 offen offset:1024 sc1
    v_exp_f32 v192, v192
    v_exp_f32 v193, v193
    v_exp_f32 v194, v194
    v_mfma_f32_32x32x16_bf16 v[160:175], a[24:27], v[240:243], v[160:175]
    buffer_load_dwordx4 v177, s[28:31], s70 offen offset:1024  lds
    v_exp_f32 v195, v195
    v_cvt_pk_bf16_f32 v248, v192, v193
    v_cvt_pk_bf16_f32 v249, v194, v195
    v_exp_f32 v196, v196
    v_mfma_f32_32x32x16_bf16 v[96:111], v[128:131], a[148:151], v[96:111]
    ds_read_b64_tr_b16 v[142:143], v183 offset:2560
    v_exp_f32 v197, v197
    v_exp_f32 v198, v198
    v_exp_f32 v199, v199
    v_mfma_f32_32x32x16_bf16 v[48:63], a[20:23], a[252:255], v[48:63]
    v_cvt_pk_bf16_f32 v250, v196, v197
    v_cvt_pk_bf16_f32 v251, v198, v199
    v_exp_f32 v200, v200
    v_exp_f32 v201, v201
    v_exp_f32 v202, v202
    v_mfma_f32_32x32x16_bf16 v[160:175], a[28:31], v[244:247], v[160:175]
    v_exp_f32 v203, v203
    v_cvt_pk_bf16_f32 v252, v200, v201
    v_cvt_pk_bf16_f32 v253, v202, v203
    v_exp_f32 v204, v204
    v_mfma_f32_32x32x16_bf16 v[112:127], v[132:135], a[148:151], v[112:127]
    s_waitcnt vmcnt(24) lgkmcnt(0)
    v_exp_f32 v205, v205
    v_exp_f32 v206, v206
    v_exp_f32 v207, v207
    v_cvt_pk_bf16_f32 v254, v204, v205
    v_cvt_pk_bf16_f32 v255, v206, v207
    v_mfma_f32_32x32x16_bf16 v[192:207], a[16:19], a[224:227], 0
    buffer_load_dwordx4 a[8:11], v36, s[20:23], s67 offen offset:0 sc1
    v_exp_f32 v48, v48
    v_exp_f32 v49, v49
    v_exp_f32 v50, v50
    v_mfma_f32_32x32x16_bf16 v[208:223], a[24:27], v[248:251], v[208:223]
    buffer_load_dwordx4 v178, s[28:31], s70 offen offset:2048  lds
    v_exp_f32 v51, v51
    v_cvt_pk_bf16_f32 v240, v48, v49
    v_cvt_pk_bf16_f32 v241, v50, v51
    v_exp_f32 v52, v52
    v_mfma_f32_32x32x16_bf16 v[64:79], v[136:139], a[152:155], v[64:79]
    ds_read_b64_tr_b16 v[128:129], v182 offset:4096
    v_exp_f32 v53, v53
    v_exp_f32 v54, v54
    v_exp_f32 v55, v55
    v_cvt_pk_bf16_f32 v242, v52, v53
    v_cvt_pk_bf16_f32 v243, v54, v55
    v_mfma_f32_32x32x16_bf16 v[192:207], a[20:23], a[228:231], v[192:207]
    v_exp_f32 v56, v56
    v_exp_f32 v57, v57
    v_exp_f32 v58, v58
    v_exp_f32 v59, v59
    v_mfma_f32_32x32x16_bf16 v[208:223], a[28:31], v[252:255], v[208:223]
    buffer_load_dwordx4 v179, s[28:31], s70 offen offset:3072  lds
    v_cvt_pk_bf16_f32 v244, v56, v57
    v_cvt_pk_bf16_f32 v245, v58, v59
    v_exp_f32 v60, v60
    v_exp_f32 v61, v61
    v_mfma_f32_32x32x16_bf16 v[80:95], v[140:143], a[152:155], v[80:95]
    s_add_u32 s70, s70, 28672
    ds_read_b64_tr_b16 v[130:131], v182 offset:4608
    ds_read_b64_tr_b16 v[132:133], v183 offset:4096
    v_exp_f32 v62, v62
    v_exp_f32 v63, v63
    v_cvt_pk_bf16_f32 v246, v60, v61
    v_cvt_pk_bf16_f32 v247, v62, v63
    v_mfma_f32_32x32x16_bf16 v[48:63], a[32:35], a[232:235], 0
    buffer_load_dwordx4 a[12:15], v36, s[20:23], s67 offen offset:1024 sc1
    v_exp_f32 v192, v192
    v_exp_f32 v193, v193
    v_exp_f32 v194, v194
    v_mfma_f32_32x32x16_bf16 v[224:239], a[24:27], v[240:243], v[224:239]
    buffer_load_dwordx4 a[192:195], v0, s[20:23], s68 offen offset:2048 sc1
    v_exp_f32 v195, v195
    v_cvt_pk_bf16_f32 v248, v192, v193
    v_cvt_pk_bf16_f32 v249, v194, v195
    v_exp_f32 v196, v196
    v_mfma_f32_32x32x16_bf16 v[96:111], v[136:139], a[156:159], v[96:111]
    s_cmp_eq_u32 s70, s84
    ds_read_b64_tr_b16 v[134:135], v183 offset:4608
    v_exp_f32 v197, v197
    v_exp_f32 v198, v198
    v_exp_f32 v199, v199
    v_cvt_pk_bf16_f32 v250, v196, v197
    v_mfma_f32_32x32x16_bf16 v[48:63], a[36:39], a[236:239], v[48:63]
    s_cselect_b32 s70, s79, s70
    v_cvt_pk_bf16_f32 v251, v198, v199
    v_exp_f32 v200, v200
    v_exp_f32 v201, v201
    v_exp_f32 v202, v202
    v_mfma_f32_32x32x16_bf16 v[224:239], a[28:31], v[244:247], v[224:239]
    buffer_load_dwordx4 a[196:199], v186, s[20:23], s68 offen offset:2048 sc1
    v_exp_f32 v203, v203
    v_cvt_pk_bf16_f32 v252, v200, v201
    v_cvt_pk_bf16_f32 v253, v202, v203
    v_exp_f32 v204, v204
    v_mfma_f32_32x32x16_bf16 v[112:127], v[140:143], a[156:159], v[112:127]
    s_waitcnt vmcnt(26) lgkmcnt(0)
    v_exp_f32 v205, v205
    v_exp_f32 v206, v206
    v_exp_f32 v207, v207
    v_cvt_pk_bf16_f32 v254, v204, v205
    v_cvt_pk_bf16_f32 v255, v206, v207
    v_mfma_f32_32x32x16_bf16 v[192:207], a[32:35], a[240:243], 0
    buffer_load_dwordx4 a[200:203], v0, s[20:23], s68 offen offset:3072 sc1
    v_exp_f32 v48, v48
    v_exp_f32 v49, v49
    v_exp_f32 v50, v50
    v_mfma_f32_32x32x16_bf16 v[144:159], a[24:27], v[248:251], v[144:159]
    buffer_load_dwordx4 a[204:207], v186, s[20:23], s68 offen offset:3072 sc1
    v_exp_f32 v51, v51
    v_cvt_pk_bf16_f32 v240, v48, v49
    v_cvt_pk_bf16_f32 v241, v50, v51
    v_exp_f32 v52, v52
    v_mfma_f32_32x32x16_bf16 v[64:79], v[128:131], a[160:163], v[64:79]
    s_add_u32 s68, s68, 4096
    ds_read_b64_tr_b16 v[136:137], v182 offset:6144
    v_exp_f32 v53, v53
    v_exp_f32 v54, v54
    v_exp_f32 v55, v55
    v_cvt_pk_bf16_f32 v242, v52, v53
    v_cvt_pk_bf16_f32 v243, v54, v55
    v_mfma_f32_32x32x16_bf16 v[192:207], a[36:39], a[244:247], v[192:207]
    s_cmp_eq_u32 s68, s78
    v_exp_f32 v56, v56
    v_exp_f32 v57, v57
    v_exp_f32 v58, v58
    v_exp_f32 v59, v59
    v_mfma_f32_32x32x16_bf16 v[144:159], a[28:31], v[252:255], v[144:159]
    s_cselect_b32 s68, s77, s68
    s_add_u32 m0, s71, 8192
    s_nop 0
    buffer_load_dwordx4 v176, s[28:31], s70 offen offset:0  lds
    v_cvt_pk_bf16_f32 v244, v56, v57
    v_cvt_pk_bf16_f32 v245, v58, v59
    v_exp_f32 v60, v60
    v_exp_f32 v61, v61
    v_mfma_f32_32x32x16_bf16 v[80:95], v[132:135], a[160:163], v[80:95]
    ds_read_b64_tr_b16 v[138:139], v182 offset:6656
    ds_read_b64_tr_b16 v[140:141], v183 offset:6144
    v_exp_f32 v62, v62
    v_exp_f32 v63, v63
    v_cvt_pk_bf16_f32 v246, v60, v61
    v_cvt_pk_bf16_f32 v247, v62, v63
    v_mfma_f32_32x32x16_bf16 v[48:63], a[32:35], a[248:251], 0
    buffer_load_dwordx4 v177, s[28:31], s70 offen offset:1024  lds
    v_exp_f32 v192, v192
    v_exp_f32 v193, v193
    v_exp_f32 v194, v194
    v_mfma_f32_32x32x16_bf16 v[160:175], a[40:43], v[240:243], v[160:175]
    buffer_load_dwordx4 v178, s[28:31], s70 offen offset:2048  lds
    v_exp_f32 v195, v195
    v_cvt_pk_bf16_f32 v248, v192, v193
    v_cvt_pk_bf16_f32 v249, v194, v195
    v_exp_f32 v196, v196
    v_mfma_f32_32x32x16_bf16 v[96:111], v[128:131], a[164:167], v[96:111]
    ds_read_b64_tr_b16 v[142:143], v183 offset:6656
    v_exp_f32 v197, v197
    v_exp_f32 v198, v198
    v_exp_f32 v199, v199
    v_cvt_pk_bf16_f32 v250, v196, v197
    v_mfma_f32_32x32x16_bf16 v[48:63], a[36:39], a[252:255], v[48:63]
    v_cvt_pk_bf16_f32 v251, v198, v199
    v_exp_f32 v200, v200
    v_exp_f32 v201, v201
    v_exp_f32 v202, v202
    v_mfma_f32_32x32x16_bf16 v[160:175], a[44:47], v[244:247], v[160:175]
    buffer_load_dwordx4 v179, s[28:31], s70 offen offset:3072  lds
    v_exp_f32 v203, v203
    v_cvt_pk_bf16_f32 v252, v200, v201
    v_cvt_pk_bf16_f32 v253, v202, v203
    v_exp_f32 v204, v204
    v_mfma_f32_32x32x16_bf16 v[112:127], v[132:135], a[164:167], v[112:127]
    s_waitcnt vmcnt(29) lgkmcnt(0)
    v_exp_f32 v205, v205
    v_exp_f32 v206, v206
    v_exp_f32 v207, v207
    v_cvt_pk_bf16_f32 v254, v204, v205
    v_cvt_pk_bf16_f32 v255, v206, v207
    v_mfma_f32_32x32x16_bf16 v[192:207], a[32:35], a[224:227], 0
    buffer_load_dwordx4 a[208:211], v0, s[20:23], s68 offen offset:0 sc1
    v_exp_f32 v48, v48
    v_exp_f32 v49, v49
    v_exp_f32 v50, v50
    v_mfma_f32_32x32x16_bf16 v[208:223], a[40:43], v[248:251], v[208:223]
    buffer_load_dwordx4 a[212:215], v186, s[20:23], s68 offen offset:0 sc1
    v_exp_f32 v51, v51
    v_cvt_pk_bf16_f32 v240, v48, v49
    v_cvt_pk_bf16_f32 v241, v50, v51
    v_exp_f32 v52, v52
    v_mfma_f32_32x32x16_bf16 v[64:79], v[136:139], a[168:171], v[64:79]
    s_waitcnt vmcnt(27)
    ds_read_b64_tr_b16 v[128:129], v180 offset:0
    v_exp_f32 v53, v53
    v_exp_f32 v54, v54
    v_exp_f32 v55, v55
    v_cvt_pk_bf16_f32 v242, v52, v53
    v_cvt_pk_bf16_f32 v243, v54, v55
    v_mfma_f32_32x32x16_bf16 v[192:207], a[36:39], a[228:231], v[192:207]
    s_add_u32 s70, s70, 28672
    v_exp_f32 v56, v56
    v_exp_f32 v57, v57
    v_exp_f32 v58, v58
    v_exp_f32 v59, v59
    v_mfma_f32_32x32x16_bf16 v[208:223], a[44:47], v[252:255], v[208:223]
    buffer_load_dwordx4 a[216:219], v0, s[20:23], s68 offen offset:1024 sc1
    v_cvt_pk_bf16_f32 v244, v56, v57
    v_cvt_pk_bf16_f32 v245, v58, v59
    v_exp_f32 v60, v60
    v_exp_f32 v61, v61
    v_mfma_f32_32x32x16_bf16 v[80:95], v[140:143], a[168:171], v[80:95]
    ds_read_b64_tr_b16 v[130:131], v180 offset:512
    ds_read_b64_tr_b16 v[132:133], v181 offset:0
    v_exp_f32 v62, v62
    v_exp_f32 v63, v63
    v_cvt_pk_bf16_f32 v246, v60, v61
    v_cvt_pk_bf16_f32 v247, v62, v63
    v_mfma_f32_32x32x16_bf16 v[48:63], a[48:51], a[232:235], 0
    buffer_load_dwordx4 a[220:223], v186, s[20:23], s68 offen offset:1024 sc1
    v_exp_f32 v192, v192
    v_exp_f32 v193, v193
    v_exp_f32 v194, v194
    v_mfma_f32_32x32x16_bf16 v[224:239], a[40:43], v[240:243], v[224:239]
    s_add_u32 m0, s71, 12288
    s_nop 0
    buffer_load_dwordx4 v176, s[28:31], s70 offen offset:0  lds
    v_exp_f32 v195, v195
    v_cvt_pk_bf16_f32 v248, v192, v193
    v_cvt_pk_bf16_f32 v249, v194, v195
    v_exp_f32 v196, v196
    v_mfma_f32_32x32x16_bf16 v[96:111], v[136:139], a[172:175], v[96:111]
    ds_read_b64_tr_b16 v[134:135], v181 offset:512
    v_exp_f32 v197, v197
    v_exp_f32 v198, v198
    v_exp_f32 v199, v199
    v_cvt_pk_bf16_f32 v250, v196, v197
    v_mfma_f32_32x32x16_bf16 v[48:63], a[52:55], a[236:239], v[48:63]
    v_cvt_pk_bf16_f32 v251, v198, v199
    v_exp_f32 v200, v200
    v_exp_f32 v201, v201
    v_exp_f32 v202, v202
    v_mfma_f32_32x32x16_bf16 v[224:239], a[44:47], v[244:247], v[224:239]
    buffer_load_dwordx4 v177, s[28:31], s70 offen offset:1024  lds
    v_exp_f32 v203, v203
    v_cvt_pk_bf16_f32 v252, v200, v201
    v_cvt_pk_bf16_f32 v253, v202, v203
    v_exp_f32 v204, v204
    v_mfma_f32_32x32x16_bf16 v[112:127], v[140:143], a[172:175], v[112:127]
    s_waitcnt vmcnt(24) lgkmcnt(0)
    v_exp_f32 v205, v205
    v_exp_f32 v206, v206
    v_exp_f32 v207, v207
    v_cvt_pk_bf16_f32 v254, v204, v205
    v_cvt_pk_bf16_f32 v255, v206, v207
    v_mfma_f32_32x32x16_bf16 v[192:207], a[48:51], a[240:243], 0
    buffer_load_dwordx4 v178, s[28:31], s70 offen offset:2048  lds
    v_exp_f32 v48, v48
    v_exp_f32 v49, v49
    v_exp_f32 v50, v50
    v_mfma_f32_32x32x16_bf16 v[144:159], a[40:43], v[248:251], v[144:159]
    buffer_load_dwordx4 v179, s[28:31], s70 offen offset:3072  lds
    v_exp_f32 v51, v51
    v_cvt_pk_bf16_f32 v240, v48, v49
    v_cvt_pk_bf16_f32 v241, v50, v51
    v_exp_f32 v52, v52
    v_mfma_f32_32x32x16_bf16 v[64:79], v[128:131], a[176:179], v[64:79]
    s_add_u32 s70, s70, 28672
    ds_read_b64_tr_b16 v[136:137], v180 offset:2048
    v_exp_f32 v53, v53
    v_exp_f32 v54, v54
    v_exp_f32 v55, v55
    v_cvt_pk_bf16_f32 v242, v52, v53
    v_cvt_pk_bf16_f32 v243, v54, v55
    v_mfma_f32_32x32x16_bf16 v[192:207], a[52:55], a[244:247], v[192:207]
    s_cmp_eq_u32 s70, s84
    v_exp_f32 v56, v56
    v_exp_f32 v57, v57
    v_exp_f32 v58, v58
    v_exp_f32 v59, v59
    v_mfma_f32_32x32x16_bf16 v[144:159], a[44:47], v[252:255], v[144:159]
    buffer_load_dwordx4 a[80:83], v0, s[20:23], s68 offen offset:2048 sc1
    v_cvt_pk_bf16_f32 v244, v56, v57
    v_cvt_pk_bf16_f32 v245, v58, v59
    v_exp_f32 v60, v60
    v_exp_f32 v61, v61
    v_mfma_f32_32x32x16_bf16 v[80:95], v[132:135], a[176:179], v[80:95]
    s_cselect_b32 s70, s79, s70
    ds_read_b64_tr_b16 v[138:139], v180 offset:2560
    ds_read_b64_tr_b16 v[140:141], v181 offset:2048
    v_exp_f32 v62, v62
    v_exp_f32 v63, v63
    v_cvt_pk_bf16_f32 v246, v60, v61
    v_cvt_pk_bf16_f32 v247, v62, v63
    v_mfma_f32_32x32x16_bf16 v[48:63], a[48:51], a[248:251], 0
    buffer_load_dwordx4 a[84:87], v186, s[20:23], s68 offen offset:2048 sc1
    v_exp_f32 v192, v192
    v_exp_f32 v193, v193
    v_exp_f32 v194, v194
    v_mfma_f32_32x32x16_bf16 v[160:175], a[56:59], v[240:243], v[160:175]
    buffer_load_dwordx4 a[88:91], v0, s[20:23], s68 offen offset:3072 sc1
    v_exp_f32 v195, v195
    v_cvt_pk_bf16_f32 v248, v192, v193
    v_cvt_pk_bf16_f32 v249, v194, v195
    v_exp_f32 v196, v196
    v_mfma_f32_32x32x16_bf16 v[96:111], v[128:131], a[180:183], v[96:111]
    ds_read_b64_tr_b16 v[142:143], v181 offset:2560
    v_exp_f32 v197, v197
    v_exp_f32 v198, v198
    v_exp_f32 v199, v199
    v_cvt_pk_bf16_f32 v250, v196, v197
    v_mfma_f32_32x32x16_bf16 v[48:63], a[52:55], a[252:255], v[48:63]
    v_cvt_pk_bf16_f32 v251, v198, v199
    v_exp_f32 v200, v200
    v_exp_f32 v201, v201
    v_exp_f32 v202, v202
    v_mfma_f32_32x32x16_bf16 v[160:175], a[60:63], v[244:247], v[160:175]
    buffer_load_dwordx4 a[92:95], v186, s[20:23], s68 offen offset:3072 sc1
    v_exp_f32 v203, v203
    v_cvt_pk_bf16_f32 v252, v200, v201
    v_cvt_pk_bf16_f32 v253, v202, v203
    v_exp_f32 v204, v204
    v_mfma_f32_32x32x16_bf16 v[112:127], v[132:135], a[180:183], v[112:127]
    s_waitcnt vmcnt(27) lgkmcnt(0)
    v_exp_f32 v205, v205
    v_exp_f32 v206, v206
    v_exp_f32 v207, v207
    v_cvt_pk_bf16_f32 v254, v204, v205
    v_cvt_pk_bf16_f32 v255, v206, v207
    v_mfma_f32_32x32x16_bf16 v[192:207], a[48:51], a[224:227], 0
    s_add_u32 s68, s68, 4096
    s_cmp_eq_u32 s68, s78
    s_cselect_b32 s68, s77, s68
    s_add_u32 m0, s73, 0
    s_nop 0
    buffer_load_dwordx4 v176, s[28:31], s70 offen offset:0  lds
    v_exp_f32 v48, v48
    v_exp_f32 v49, v49
    v_exp_f32 v50, v50
    v_mfma_f32_32x32x16_bf16 v[208:223], a[56:59], v[248:251], v[208:223]
    buffer_load_dwordx4 v177, s[28:31], s70 offen offset:1024  lds
    v_exp_f32 v51, v51
    v_cvt_pk_bf16_f32 v240, v48, v49
    v_cvt_pk_bf16_f32 v241, v50, v51
    v_exp_f32 v52, v52
    v_mfma_f32_32x32x16_bf16 v[64:79], v[136:139], a[184:187], v[64:79]
    s_waitcnt vmcnt(26)
    ds_read_b64_tr_b16 v[128:129], v180 offset:4096
    v_exp_f32 v53, v53
    v_exp_f32 v54, v54
    v_exp_f32 v55, v55
    v_cvt_pk_bf16_f32 v242, v52, v53
    v_cvt_pk_bf16_f32 v243, v54, v55
    v_mfma_f32_32x32x16_bf16 v[192:207], a[52:55], a[228:231], v[192:207]
    v_exp_f32 v56, v56
    v_exp_f32 v57, v57
    v_exp_f32 v58, v58
    v_exp_f32 v59, v59
    v_mfma_f32_32x32x16_bf16 v[208:223], a[60:63], v[252:255], v[208:223]
    buffer_load_dwordx4 v178, s[28:31], s70 offen offset:2048  lds
    v_cvt_pk_bf16_f32 v244, v56, v57
    v_cvt_pk_bf16_f32 v245, v58, v59
    v_exp_f32 v60, v60
    v_exp_f32 v61, v61
    v_mfma_f32_32x32x16_bf16 v[80:95], v[140:143], a[184:187], v[80:95]
    ds_read_b64_tr_b16 v[130:131], v180 offset:4608
    ds_read_b64_tr_b16 v[132:133], v181 offset:4096
    v_exp_f32 v62, v62
    v_exp_f32 v63, v63
    v_cvt_pk_bf16_f32 v246, v60, v61
    v_cvt_pk_bf16_f32 v247, v62, v63
    v_mfma_f32_32x32x16_bf16 v[48:63], a[64:67], a[232:235], 0
    buffer_load_dwordx4 v179, s[28:31], s70 offen offset:3072  lds
    v_exp_f32 v192, v192
    v_exp_f32 v193, v193
    v_exp_f32 v194, v194
    v_mfma_f32_32x32x16_bf16 v[224:239], a[56:59], v[240:243], v[224:239]
    buffer_load_dwordx4 a[96:99], v0, s[20:23], s68 offen offset:0 sc1
    v_exp_f32 v195, v195
    v_cvt_pk_bf16_f32 v248, v192, v193
    v_cvt_pk_bf16_f32 v249, v194, v195
    v_exp_f32 v196, v196
    v_mfma_f32_32x32x16_bf16 v[96:111], v[136:139], a[188:191], v[96:111]
    s_add_u32 s70, s70, 28672
    ds_read_b64_tr_b16 v[134:135], v181 offset:4608
    v_exp_f32 v197, v197
    v_exp_f32 v198, v198
    v_exp_f32 v199, v199
    v_cvt_pk_bf16_f32 v250, v196, v197
    v_mfma_f32_32x32x16_bf16 v[48:63], a[68:71], a[236:239], v[48:63]
    v_cvt_pk_bf16_f32 v251, v198, v199
    v_exp_f32 v200, v200
    v_exp_f32 v201, v201
    v_exp_f32 v202, v202
    v_mfma_f32_32x32x16_bf16 v[224:239], a[60:63], v[244:247], v[224:239]
    buffer_load_dwordx4 a[100:103], v186, s[20:23], s68 offen offset:0 sc1
    v_exp_f32 v203, v203
    v_cvt_pk_bf16_f32 v252, v200, v201
    v_cvt_pk_bf16_f32 v253, v202, v203
    v_exp_f32 v204, v204
    v_mfma_f32_32x32x16_bf16 v[112:127], v[140:143], a[188:191], v[112:127]
    s_waitcnt vmcnt(24) lgkmcnt(0)
    v_exp_f32 v205, v205
    v_exp_f32 v206, v206
    v_exp_f32 v207, v207
    v_cvt_pk_bf16_f32 v254, v204, v205
    v_cvt_pk_bf16_f32 v255, v206, v207
    v_mfma_f32_32x32x16_bf16 v[192:207], a[64:67], a[240:243], 0
    buffer_load_dwordx4 a[104:107], v0, s[20:23], s68 offen offset:1024 sc1
    v_exp_f32 v48, v48
    v_exp_f32 v49, v49
    v_exp_f32 v50, v50
    v_mfma_f32_32x32x16_bf16 v[144:159], a[56:59], v[248:251], v[144:159]
    buffer_load_dwordx4 a[108:111], v186, s[20:23], s68 offen offset:1024 sc1
    v_exp_f32 v51, v51
    v_cvt_pk_bf16_f32 v240, v48, v49
    v_cvt_pk_bf16_f32 v241, v50, v51
    v_exp_f32 v52, v52
    v_mfma_f32_32x32x16_bf16 v[64:79], v[128:131], a[192:195], v[64:79]
    s_add_u32 m0, s73, 4096
    ds_read_b64_tr_b16 v[136:137], v180 offset:6144
    v_exp_f32 v53, v53
    v_exp_f32 v54, v54
    v_exp_f32 v55, v55
    v_cvt_pk_bf16_f32 v242, v52, v53
    v_cvt_pk_bf16_f32 v243, v54, v55
    v_mfma_f32_32x32x16_bf16 v[192:207], a[68:71], a[244:247], v[192:207]
    v_exp_f32 v56, v56
    v_exp_f32 v57, v57
    v_exp_f32 v58, v58
    v_exp_f32 v59, v59
    v_mfma_f32_32x32x16_bf16 v[144:159], a[60:63], v[252:255], v[144:159]
    buffer_load_dwordx4 v176, s[28:31], s70 offen offset:0  lds
    v_cvt_pk_bf16_f32 v244, v56, v57
    v_cvt_pk_bf16_f32 v245, v58, v59
    v_exp_f32 v60, v60
    v_exp_f32 v61, v61
    v_mfma_f32_32x32x16_bf16 v[80:95], v[132:135], a[192:195], v[80:95]
    ds_read_b64_tr_b16 v[138:139], v180 offset:6656
    ds_read_b64_tr_b16 v[140:141], v181 offset:6144
    v_exp_f32 v62, v62
    v_exp_f32 v63, v63
    v_cvt_pk_bf16_f32 v246, v60, v61
    v_cvt_pk_bf16_f32 v247, v62, v63
    v_mfma_f32_32x32x16_bf16 v[48:63], a[64:67], a[248:251], 0
    buffer_load_dword v35, v38, s[20:23], s49 offen sc1
    v_exp_f32 v192, v192
    v_exp_f32 v193, v193
    v_exp_f32 v194, v194
    v_mfma_f32_32x32x16_bf16 v[160:175], a[72:75], v[240:243], v[160:175]
    buffer_load_dwordx4 v177, s[28:31], s70 offen offset:1024  lds
    v_exp_f32 v195, v195
    v_cvt_pk_bf16_f32 v248, v192, v193
    v_cvt_pk_bf16_f32 v249, v194, v195
    v_exp_f32 v196, v196
    v_mfma_f32_32x32x16_bf16 v[96:111], v[128:131], a[196:199], v[96:111]
    ds_read_b64_tr_b16 v[142:143], v181 offset:6656
    v_exp_f32 v197, v197
    v_exp_f32 v198, v198
    v_exp_f32 v199, v199
    v_cvt_pk_bf16_f32 v250, v196, v197
    v_mfma_f32_32x32x16_bf16 v[48:63], a[68:71], a[252:255], v[48:63]
    v_cvt_pk_bf16_f32 v251, v198, v199
    v_exp_f32 v200, v200
    v_exp_f32 v201, v201
    v_exp_f32 v202, v202
    v_mfma_f32_32x32x16_bf16 v[160:175], a[76:79], v[244:247], v[160:175]
    buffer_load_dwordx4 v178, s[28:31], s70 offen offset:2048  lds
    v_exp_f32 v203, v203
    v_cvt_pk_bf16_f32 v252, v200, v201
    v_cvt_pk_bf16_f32 v253, v202, v203
    v_exp_f32 v204, v204
    v_mfma_f32_32x32x16_bf16 v[112:127], v[132:135], a[196:199], v[112:127]
    s_waitcnt vmcnt(28) lgkmcnt(0)
    v_exp_f32 v205, v205
    v_exp_f32 v206, v206
    v_exp_f32 v207, v207
    v_cvt_pk_bf16_f32 v254, v204, v205
    v_cvt_pk_bf16_f32 v255, v206, v207
    v_mfma_f32_32x32x16_bf16 v[192:207], a[64:67], a[224:227], 0
    buffer_load_dwordx4 v179, s[28:31], s70 offen offset:3072  lds
    v_exp_f32 v48, v48
    v_exp_f32 v49, v49
    v_exp_f32 v50, v50
    v_mfma_f32_32x32x16_bf16 v[208:223], a[72:75], v[248:251], v[208:223]
    buffer_load_dwordx4 a[112:115], v0, s[20:23], s68 offen offset:2048 sc1
    v_exp_f32 v51, v51
    v_cvt_pk_bf16_f32 v240, v48, v49
    v_cvt_pk_bf16_f32 v241, v50, v51
    v_exp_f32 v52, v52
    v_mfma_f32_32x32x16_bf16 v[64:79], v[136:139], a[200:203], v[64:79]
    s_waitcnt vmcnt(28)
    ds_read_b64_tr_b16 v[128:129], v180 offset:8192
    v_exp_f32 v53, v53
    v_exp_f32 v54, v54
    v_exp_f32 v55, v55
    v_cvt_pk_bf16_f32 v242, v52, v53
    v_cvt_pk_bf16_f32 v243, v54, v55
    v_mfma_f32_32x32x16_bf16 v[192:207], a[68:71], a[228:231], v[192:207]
    s_add_u32 s70, s70, 28672
    v_exp_f32 v56, v56
    v_exp_f32 v57, v57
    v_exp_f32 v58, v58
    v_exp_f32 v59, v59
    v_mfma_f32_32x32x16_bf16 v[208:223], a[76:79], v[252:255], v[208:223]
    buffer_load_dwordx4 a[116:119], v186, s[20:23], s68 offen offset:2048 sc1
    v_cvt_pk_bf16_f32 v244, v56, v57
    v_cvt_pk_bf16_f32 v245, v58, v59
    v_exp_f32 v60, v60
    v_exp_f32 v61, v61
    v_mfma_f32_32x32x16_bf16 v[80:95], v[140:143], a[200:203], v[80:95]
    s_cmp_eq_u32 s70, s84
    ds_read_b64_tr_b16 v[130:131], v180 offset:8704
    ds_read_b64_tr_b16 v[132:133], v181 offset:8192
    v_exp_f32 v62, v62
    v_exp_f32 v63, v63
    v_cvt_pk_bf16_f32 v246, v60, v61
    v_cvt_pk_bf16_f32 v247, v62, v63
    v_mfma_f32_32x32x16_bf16 v[48:63], a[0:3], a[232:235], 0
    buffer_load_dwordx4 a[120:123], v0, s[20:23], s68 offen offset:3072 sc1
    v_exp_f32 v192, v192
    v_exp_f32 v193, v193
    v_exp_f32 v194, v194
    v_mfma_f32_32x32x16_bf16 v[224:239], a[72:75], v[240:243], v[224:239]
    buffer_load_dwordx4 a[124:127], v186, s[20:23], s68 offen offset:3072 sc1
    v_exp_f32 v195, v195
    v_cvt_pk_bf16_f32 v248, v192, v193
    v_cvt_pk_bf16_f32 v249, v194, v195
    v_exp_f32 v196, v196
    v_mfma_f32_32x32x16_bf16 v[96:111], v[136:139], a[204:207], v[96:111]
    s_cselect_b32 s70, s79, s70
    ds_read_b64_tr_b16 v[134:135], v181 offset:8704
    v_exp_f32 v197, v197
    v_exp_f32 v198, v198
    v_exp_f32 v199, v199
    v_cvt_pk_bf16_f32 v250, v196, v197
    v_mfma_f32_32x32x16_bf16 v[48:63], a[4:7], a[236:239], v[48:63]
    s_add_u32 s68, s68, 4096
    v_cvt_pk_bf16_f32 v251, v198, v199
    v_exp_f32 v200, v200
    v_exp_f32 v201, v201
    v_exp_f32 v202, v202
    v_mfma_f32_32x32x16_bf16 v[224:239], a[76:79], v[244:247], v[224:239]
    s_cmp_eq_u32 s68, s78
    s_cselect_b32 s68, s77, s68
    buffer_load_dwordx4 a[128:131], v0, s[20:23], s68 offen offset:0 sc1
    v_exp_f32 v203, v203
    v_cvt_pk_bf16_f32 v252, v200, v201
    v_cvt_pk_bf16_f32 v253, v202, v203
    v_exp_f32 v204, v204
    v_mfma_f32_32x32x16_bf16 v[112:127], v[140:143], a[204:207], v[112:127]
    v_exp_f32 v205, v205
    v_exp_f32 v206, v206
    v_exp_f32 v207, v207
    v_cvt_pk_bf16_f32 v254, v204, v205
    v_cvt_pk_bf16_f32 v255, v206, v207
    v_mfma_f32_32x32x16_bf16 v[192:207], a[0:3], a[240:243], 0
    buffer_load_dwordx4 a[132:135], v186, s[20:23], s68 offen offset:0 sc1
    s_waitcnt vmcnt(25)
    ds_read_b64_tr_b16 v[14:15], v180 offset:12288
    ds_read_b64_tr_b16 v[16:17], v180 offset:12800
    v_exp_f32 v48, v48
    v_exp_f32 v49, v49
    v_exp_f32 v50, v50
    v_exp_f32 v51, v51
    v_cvt_pk_bf16_f32 v240, v48, v49
    v_mfma_f32_32x32x16_bf16 v[144:159], a[72:75], v[248:251], v[144:159]
    buffer_load_dwordx4 a[136:139], v0, s[20:23], s68 offen offset:1024 sc1
    ds_read_b64_tr_b16 v[18:19], v181 offset:12288
    v_cvt_pk_bf16_f32 v241, v50, v51
    v_exp_f32 v52, v52
    v_exp_f32 v53, v53
    v_exp_f32 v54, v54
    v_exp_f32 v55, v55
    v_cvt_pk_bf16_f32 v242, v52, v53
    v_mfma_f32_32x32x16_bf16 v[192:207], a[4:7], a[244:247], v[192:207]
    ds_read_b64_tr_b16 v[20:21], v181 offset:12800
    s_waitcnt vmcnt(24)
    ds_read_b64_tr_b16 v[22:23], v180 offset:14336
    v_cvt_pk_bf16_f32 v243, v54, v55
    v_exp_f32 v56, v56
    v_exp_f32 v57, v57
    v_exp_f32 v58, v58
    v_exp_f32 v59, v59
    v_cvt_pk_bf16_f32 v244, v56, v57
    v_cvt_pk_bf16_f32 v245, v58, v59
    v_mfma_f32_32x32x16_bf16 v[144:159], a[76:79], v[252:255], v[144:159]
    buffer_load_dwordx4 a[140:143], v186, s[20:23], s68 offen offset:1024 sc1
    ds_read_b64_tr_b16 v[24:25], v180 offset:14848
    v_exp_f32 v60, v60
    v_exp_f32 v61, v61
    v_exp_f32 v62, v62
    v_exp_f32 v63, v63
    v_cvt_pk_bf16_f32 v246, v60, v61
    v_cvt_pk_bf16_f32 v247, v62, v63
    v_mfma_f32_32x32x16_bf16 v[48:63], a[0:3], a[248:251], 0
    s_add_u32 m0, s71, 0
    s_nop 0
    buffer_load_dwordx4 v176, s[28:31], s70 offen offset:0  lds
    ds_read_b64_tr_b16 v[26:27], v181 offset:14336
    ds_read_b64_tr_b16 v[28:29], v181 offset:14848
    v_exp_f32 v192, v192
    v_exp_f32 v193, v193
    v_exp_f32 v194, v194
    v_exp_f32 v195, v195
    v_cvt_pk_bf16_f32 v248, v192, v193
    v_mfma_f32_32x32x16_bf16 v[160:175], a[8:11], v[240:243], v[160:175]
    buffer_load_dwordx4 v177, s[28:31], s70 offen offset:1024  lds
    ds_read_b64_tr_b16 v[136:137], v180 offset:10240
    v_cvt_pk_bf16_f32 v249, v194, v195
    v_exp_f32 v196, v196
    v_exp_f32 v197, v197
    v_exp_f32 v198, v198
    v_exp_f32 v199, v199
    v_cvt_pk_bf16_f32 v250, v196, v197
    v_mfma_f32_32x32x16_bf16 v[48:63], a[4:7], a[252:255], v[48:63]
    ds_read_b64_tr_b16 v[138:139], v180 offset:10752
    ds_read_b64_tr_b16 v[140:141], v181 offset:10240
    v_cvt_pk_bf16_f32 v251, v198, v199
    v_exp_f32 v200, v200
    v_exp_f32 v201, v201
    v_exp_f32 v202, v202
    v_exp_f32 v203, v203
    v_cvt_pk_bf16_f32 v252, v200, v201
    v_cvt_pk_bf16_f32 v253, v202, v203
    v_mfma_f32_32x32x16_bf16 v[160:175], a[12:15], v[244:247], v[160:175]
    buffer_load_dwordx4 v178, s[28:31], s70 offen offset:2048  lds
    ds_read_b64_tr_b16 v[142:143], v181 offset:10752
    v_exp_f32 v204, v204
    v_exp_f32 v205, v205
    v_exp_f32 v206, v206
    v_exp_f32 v207, v207
    v_cvt_pk_bf16_f32 v254, v204, v205
    v_cvt_pk_bf16_f32 v255, v206, v207
    v_mfma_f32_32x32x16_bf16 v[192:207], a[0:3], a[224:227], 0
    v_exp_f32 v48, v48
    v_exp_f32 v49, v49
    v_exp_f32 v50, v50
    v_exp_f32 v51, v51
    v_cvt_pk_bf16_f32 v240, v48, v49
    v_cvt_pk_bf16_f32 v241, v50, v51
    v_exp_f32 v52, v52
    v_mfma_f32_32x32x16_bf16 v[208:223], a[8:11], v[248:251], v[208:223]
    ds_write_b128 v187, v[160:163] offset:8192
    v_exp_f32 v53, v53
    v_exp_f32 v54, v54
    v_exp_f32 v55, v55
    v_cvt_pk_bf16_f32 v242, v52, v53
    v_cvt_pk_bf16_f32 v243, v54, v55
    v_exp_f32 v56, v56
    v_mfma_f32_32x32x16_bf16 v[192:207], a[4:7], a[228:231], v[192:207]
    ds_write_b128 v187, v[164:167] offset:9216
    v_exp_f32 v57, v57
    v_exp_f32 v58, v58
    v_exp_f32 v59, v59
    v_cvt_pk_bf16_f32 v244, v56, v57
    v_cvt_pk_bf16_f32 v245, v58, v59
    v_exp_f32 v60, v60
    v_mfma_f32_32x32x16_bf16 v[208:223], a[12:15], v[252:255], v[208:223]
    ds_write_b128 v187, v[168:171] offset:10240
    ds_write_b128 v187, v[172:175] offset:11264
    v_exp_f32 v61, v61
    v_exp_f32 v62, v62
    v_exp_f32 v63, v63
    v_cvt_pk_bf16_f32 v246, v60, v61
    v_cvt_pk_bf16_f32 v247, v62, v63
    v_mfma_f32_32x32x16_bf16 v[224:239], a[8:11], v[240:243], v[224:239]
    s_waitcnt vmcnt(22)
    ds_read_b64_tr_b16 v[48:49], v182 offset:0
    ds_read_b64_tr_b16 v[50:51], v182 offset:512
    ds_read_b64_tr_b16 v[52:53], v183 offset:0
    ds_read_b64_tr_b16 v[54:55], v183 offset:512
    ds_write_b128 v187, v[208:211] offset:12288
    ds_write_b128 v187, v[212:215] offset:13312
    v_exp_f32 v192, v192
    v_exp_f32 v193, v193
    v_exp_f32 v194, v194
    v_exp_f32 v195, v195
    v_cvt_pk_bf16_f32 v248, v192, v193
    v_cvt_pk_bf16_f32 v249, v194, v195
    v_exp_f32 v196, v196
    v_exp_f32 v197, v197
    v_exp_f32 v198, v198
    v_exp_f32 v199, v199
    v_cvt_pk_bf16_f32 v250, v196, v197
    v_cvt_pk_bf16_f32 v251, v198, v199
    v_mfma_f32_32x32x16_bf16 v[224:239], a[12:15], v[244:247], v[224:239]
    s_waitcnt vmcnt(20)
    ds_read_b64_tr_b16 v[56:57], v182 offset:2048
    ds_read_b64_tr_b16 v[58:59], v182 offset:2560
    ds_read_b64_tr_b16 v[60:61], v183 offset:2048
    ds_read_b64_tr_b16 v[62:63], v183 offset:2560
    ds_write_b128 v187, v[216:219] offset:14336
    ds_write_b128 v187, v[220:223] offset:15360
    v_exp_f32 v200, v200
    v_exp_f32 v201, v201
    v_exp_f32 v202, v202
    v_exp_f32 v203, v203
    v_cvt_pk_bf16_f32 v252, v200, v201
    v_cvt_pk_bf16_f32 v253, v202, v203
    v_exp_f32 v204, v204
    v_exp_f32 v205, v205
    v_exp_f32 v206, v206
    v_exp_f32 v207, v207
    v_cvt_pk_bf16_f32 v254, v204, v205
    v_cvt_pk_bf16_f32 v255, v206, v207
    v_mfma_f32_32x32x16_bf16 v[144:159], a[8:11], v[248:251], v[144:159]
    s_nop 0
    v_mfma_f32_32x32x16_bf16 v[144:159], a[12:15], v[252:255], v[144:159]
    ds_write_b128 v7, v[224:227] offset:0
    ds_write_b128 v7, v[228:231] offset:1024
    ds_write_b128 v7, v[232:235] offset:2048
    ds_write_b128 v7, v[236:239] offset:3072
    s_waitcnt lgkmcnt(15)
    v_mfma_f32_32x32x16_bf16 v[64:79], v[128:131], a[208:211], v[64:79]
    buffer_load_dwordx4 v179, s[28:31], s70 offen offset:3072  lds
    s_add_u32 s70, s70, 28672
    buffer_load_dwordx4 a[144:147], v0, s[20:23], s68 offen offset:2048 sc1
    v_mfma_f32_32x32x16_bf16 v[80:95], v[132:135], a[208:211], v[80:95]
    buffer_load_dwordx4 a[148:151], v186, s[20:23], s68 offen offset:2048 sc1
    buffer_load_dwordx4 a[152:155], v0, s[20:23], s68 offen offset:3072 sc1
    s_waitcnt lgkmcnt(0)
    s_barrier
    ds_read_b128 v[172:175], v188 offset:11264
    ds_read_b128 v[220:223], v189 offset:15360
    ds_read_b128 v[236:239], v190 offset:3072
    ds_read_b128 v[160:163], v188 offset:8192
    v_mfma_f32_32x32x16_bf16 v[96:111], v[128:131], a[212:215], v[96:111]
    ds_read_b128 v[208:211], v189 offset:12288
    ds_read_b128 v[224:227], v190 offset:0
    ds_read_b128 v[164:167], v188 offset:9216
    ds_read_b128 v[212:215], v189 offset:13312
    v_mfma_f32_32x32x16_bf16 v[112:127], v[132:135], a[212:215], v[112:127]
    ds_read_b128 v[228:231], v190 offset:1024
    ds_read_b128 v[168:171], v188 offset:10240
    ds_read_b128 v[216:219], v189 offset:14336
    ds_read_b128 v[232:235], v190 offset:2048
    v_mfma_f32_32x32x16_bf16 v[64:79], v[136:139], a[216:219], v[64:79]
    buffer_load_dwordx4 a[156:159], v186, s[20:23], s68 offen offset:3072 sc1
    s_add_u32 m0, s71, 4096
    s_nop 0
    buffer_load_dwordx4 v176, s[28:31], s70 offen offset:0  lds
    buffer_load_dwordx4 v177, s[28:31], s70 offen offset:1024  lds
    v_mfma_f32_32x32x16_bf16 v[80:95], v[140:143], a[216:219], v[80:95]
    buffer_load_dwordx4 v178, s[28:31], s70 offen offset:2048  lds
    buffer_load_dwordx4 v179, s[28:31], s70 offen offset:3072  lds
    s_waitcnt lgkmcnt(9)
    v_pk_add_f32 v[172:173], v[172:173], v[220:221]
    v_pk_add_f32 v[174:175], v[174:175], v[222:223]
    v_pk_add_f32 v[156:157], v[156:157], v[236:237]
    v_pk_add_f32 v[158:159], v[158:159], v[238:239]
    v_pk_add_f32 v[156:157], v[156:157], v[172:173]
    v_pk_add_f32 v[158:159], v[158:159], v[174:175]
    v_mov_b32 v41, v156
    v_mov_b32 v42, v156
    s_waitcnt lgkmcnt(6)
    v_pk_add_f32 v[160:161], v[160:161], v[208:209]
    v_pk_add_f32 v[162:163], v[162:163], v[210:211]
    v_pk_add_f32 v[144:145], v[144:145], v[224:225]
    v_pk_add_f32 v[146:147], v[146:147], v[226:227]
    v_pk_add_f32 v[144:145], v[144:145], v[160:161]
    v_pk_add_f32 v[146:147], v[146:147], v[162:163]
    v_permlane32_swap_b32 v41, v42
    s_waitcnt lgkmcnt(3)
    v_pk_add_f32 v[164:165], v[164:165], v[212:213]
    v_pk_add_f32 v[166:167], v[166:167], v[214:215]
    v_pk_add_f32 v[148:149], v[148:149], v[228:229]
    v_pk_add_f32 v[150:151], v[150:151], v[230:231]
    v_pk_add_f32 v[148:149], v[148:149], v[164:165]
    v_pk_add_f32 v[150:151], v[150:151], v[166:167]
    s_waitcnt lgkmcnt(0)
    v_pk_add_f32 v[168:169], v[168:169], v[216:217]
    v_pk_add_f32 v[170:171], v[170:171], v[218:219]
    v_pk_add_f32 v[152:153], v[152:153], v[232:233]
    v_pk_add_f32 v[154:155], v[154:155], v[234:235]
    v_pk_add_f32 v[152:153], v[152:153], v[168:169]
    v_pk_add_f32 v[154:155], v[154:155], v[170:171]
    v_max3_f32 v43, abs(v144), abs(v145), abs(v146)
    v_max3_f32 v44, abs(v147), abs(v148), abs(v149)
    v_max3_f32 v43, abs(v150), abs(v151), v43
    v_max3_f32 v44, abs(v152), abs(v153), v44
    v_max3_f32 v43, abs(v154), abs(v155), v43
    v_max3_f32 v44, abs(v156), abs(v157), v44
    v_max3_f32 v43, abs(v158), abs(v159), v43
    v_cmp_nle_f32 vcc, 0x21800000, v42
    v_max_f32 v43, v43, v44
    s_mov_b64 s[52:53], vcc
    v_cmp_nge_f32 vcc, 0x5d800000, v42
    s_or_b64 s[52:53], s[52:53], vcc
    v_cmp_nge_f32 vcc, 0x71800000, v43
    s_or_b64 s[52:53], s[52:53], vcc
    s_cbranch_scc1 L_fallback
L_norm:
    v_rcp_f32 v42, v42
    s_nop 0
    v_mul_f32 v42, v31, v42
    v_pk_mul_f32 v[144:145], v[144:145], v[42:43] op_sel_hi:[1,0]
    v_pk_mul_f32 v[146:147], v[146:147], v[42:43] op_sel_hi:[1,0]
    v_pk_mul_f32 v[148:149], v[148:149], v[42:43] op_sel_hi:[1,0]
    v_pk_mul_f32 v[150:151], v[150:151], v[42:43] op_sel_hi:[1,0]
    v_cvt_pk_bf16_f32 v144, v144, v145
    v_cvt_pk_bf16_f32 v145, v146, v147
    v_cvt_pk_bf16_f32 v146, v148, v149
    v_cvt_pk_bf16_f32 v147, v150, v151
    v_min_u32 v144, -2, v144
    v_min_u32 v145, -2, v145
    v_min_u32 v146, -2, v146
    v_min_u32 v147, -2, v147
    buffer_store_dwordx4 v[144:147], v2, s[20:23], s81 offen offset:0 sc1
    v_pk_mul_f32 v[152:153], v[152:153], v[42:43] op_sel_hi:[1,0]
    v_pk_mul_f32 v[154:155], v[154:155], v[42:43] op_sel_hi:[1,0]
    v_pk_mul_f32 v[156:157], v[156:157], v[42:43] op_sel_hi:[1,0]
    v_pk_mul_f32 v[158:159], v[158:159], v[42:43] op_sel_hi:[1,0]
    v_cvt_pk_bf16_f32 v152, v152, v153
    v_cvt_pk_bf16_f32 v153, v154, v155
    v_cvt_pk_bf16_f32 v154, v156, v157
    v_cvt_pk_bf16_f32 v155, v158, v159
    v_and_b32 v154, v37, v154
    v_and_b32 v155, v37, v155
    v_min_u32 v152, -2, v152
    v_min_u32 v153, -2, v153
    v_min_u32 v154, -2, v154
    v_min_u32 v155, -2, v155
    buffer_store_dwordx4 v[152:155], v2, s[20:23], s81 offen offset:1024 sc1
    s_waitcnt vmcnt(25)
    v_cmp_ne_u32 vcc, v35, v3
    s_cmp_lg_u32 s82, 0
    s_cbranch_scc1 L_fin
    s_and_b32 vcc_lo, vcc_lo, 0xff
    s_cbranch_scc1 L_pslow
L_pback:
    v_mfma_f32_32x32x16_bf16 v[96:111], v[136:139], a[220:223], v[96:111]
    v_xor_b32 v10, 0x8000, v184
    v_xor_b32 v11, 0x8000, v185
    ds_read_b64_tr_b16 a[16:17], v184 offset:0
    ds_read_b64_tr_b16 a[18:19], v184 offset:512
    ds_read_b64_tr_b16 a[20:21], v185 offset:0
    s_mov_b32 s56, 0x430000
    v_mfma_f32_32x32x16_bf16 v[112:127], v[140:143], a[220:223], v[112:127]
    s_waitcnt vmcnt(24)
    ds_read_b64_tr_b16 v[128:129], v182 offset:4096
    ds_read_b64_tr_b16 v[130:131], v182 offset:4608
    ds_read_b64_tr_b16 a[22:23], v185 offset:512
    s_mov_b32 s57, 0x432000
    v_mfma_f32_32x32x16_bf16 v[80:95], v[18:21], a[80:83], v[80:95]
    ds_read_b64_tr_b16 v[132:133], v183 offset:4096
    ds_read_b64_tr_b16 v[134:135], v183 offset:4608
    ds_read_b64_tr_b16 a[24:25], v184 offset:2048
    s_mov_b32 s58, 0x434000
    s_mov_b32 s59, 0x436000
    v_mfma_f32_32x32x16_bf16 v[96:111], v[14:17], a[84:87], v[96:111]
    s_waitcnt vmcnt(22)
    ds_read_b64_tr_b16 v[136:137], v182 offset:6144
    ds_read_b64_tr_b16 v[138:139], v182 offset:6656
    ds_read_b64_tr_b16 a[26:27], v184 offset:2560
    s_mov_b32 s72, 0x20000
    v_mfma_f32_32x32x16_bf16 v[112:127], v[18:21], a[84:87], v[112:127]
    ds_read_b64_tr_b16 v[140:141], v183 offset:6144
    ds_read_b64_tr_b16 v[142:143], v183 offset:6656
    ds_read_b64_tr_b16 a[28:29], v185 offset:2048
    s_mov_b32 s52, 0
    v_mfma_f32_32x32x16_bf16 v[64:79], v[14:17], a[80:83], v[64:79]
    ds_read_b64_tr_b16 a[30:31], v185 offset:2560
    ds_read_b64_tr_b16 a[160:161], v10 offset:0
    ds_read_b64_tr_b16 a[162:163], v10 offset:512
    v_mov_b32 v160, 0
    v_mfma_f32_32x32x16_bf16 v[80:95], v[26:29], a[88:91], v[80:95]
    s_waitcnt vmcnt(12)
    ds_read_b64_tr_b16 v[14:15], v180 offset:0
    ds_read_b64_tr_b16 v[16:17], v180 offset:512
    ds_read_b64_tr_b16 a[164:165], v11 offset:0
    v_mov_b32 v161, 0
    v_mfma_f32_32x32x16_bf16 v[96:111], v[22:25], a[92:95], v[96:111]
    ds_read_b64_tr_b16 v[18:19], v181 offset:0
    ds_read_b64_tr_b16 v[20:21], v181 offset:512
    ds_read_b64_tr_b16 a[166:167], v11 offset:512
    v_mfma_f32_32x32x16_bf16 v[112:127], v[26:29], a[92:95], v[112:127]
    ds_read_b64_tr_b16 a[168:169], v10 offset:2048
    ds_read_b64_tr_b16 a[170:171], v10 offset:2560
    ds_read_b64_tr_b16 a[172:173], v11 offset:2048
    v_mov_b32 v162, 0
    v_mfma_f32_32x32x16_bf16 v[64:79], v[22:25], a[88:91], v[64:79]
    ds_read_b64_tr_b16 a[174:175], v11 offset:2560
    ds_read_b64_tr_b16 a[32:33], v184 offset:4096
    ds_read_b64_tr_b16 a[34:35], v184 offset:4608
    v_mov_b32 v163, 0
    v_mfma_f32_32x32x16_bf16 v[80:95], v[52:55], a[96:99], v[80:95]
    s_waitcnt vmcnt(10)
    ds_read_b64_tr_b16 v[22:23], v180 offset:2048
    ds_read_b64_tr_b16 v[24:25], v180 offset:2560
    ds_read_b64_tr_b16 a[36:37], v185 offset:4096
    v_mov_b32 v164, 0
    v_mfma_f32_32x32x16_bf16 v[96:111], v[48:51], a[100:103], v[96:111]
    ds_read_b64_tr_b16 v[26:27], v181 offset:2048
    ds_read_b64_tr_b16 v[28:29], v181 offset:2560
    ds_read_b64_tr_b16 a[38:39], v185 offset:4608
    v_mov_b32 v165, 0
    v_mfma_f32_32x32x16_bf16 v[112:127], v[52:55], a[100:103], v[112:127]
    ds_read_b64_tr_b16 a[40:41], v184 offset:6144
    ds_read_b64_tr_b16 a[42:43], v184 offset:6656
    ds_read_b64_tr_b16 a[44:45], v185 offset:6144
    v_mfma_f32_32x32x16_bf16 v[64:79], v[48:51], a[96:99], v[64:79]
    ds_read_b64_tr_b16 a[46:47], v185 offset:6656
    ds_read_b64_tr_b16 a[176:177], v10 offset:4096
    ds_read_b64_tr_b16 a[178:179], v10 offset:4608
    v_mov_b32 v166, 0
    v_mfma_f32_32x32x16_bf16 v[80:95], v[60:63], a[104:107], v[80:95]
    s_waitcnt vmcnt(4)
    ds_read_b64_tr_b16 v[48:49], v180 offset:4096
    ds_read_b64_tr_b16 v[50:51], v180 offset:4608
    ds_read_b64_tr_b16 a[180:181], v11 offset:4096
    v_mov_b32 v167, 0
    v_mfma_f32_32x32x16_bf16 v[96:111], v[56:59], a[108:111], v[96:111]
    ds_read_b64_tr_b16 v[52:53], v181 offset:4096
    ds_read_b64_tr_b16 v[54:55], v181 offset:4608
    ds_read_b64_tr_b16 a[182:183], v11 offset:4608
    v_mov_b32 v168, 0
    v_mfma_f32_32x32x16_bf16 v[112:127], v[60:63], a[108:111], v[112:127]
    ds_read_b64_tr_b16 a[184:185], v10 offset:6144
    ds_read_b64_tr_b16 a[186:187], v10 offset:6656
    ds_read_b64_tr_b16 a[188:189], v11 offset:6144
    v_mov_b32 v169, 0
    v_mfma_f32_32x32x16_bf16 v[64:79], v[56:59], a[104:107], v[64:79]
    s_waitcnt vmcnt(2)
    ds_read_b64_tr_b16 v[56:57], v180 offset:6144
    ds_read_b64_tr_b16 v[58:59], v180 offset:6656
    ds_read_b64_tr_b16 a[190:191], v11 offset:6656
    s_waitcnt lgkmcnt(15)
    v_mfma_f32_32x32x16_bf16 v[80:95], v[132:135], a[112:115], v[80:95]
    ds_read_b64_tr_b16 v[60:61], v181 offset:6144
    ds_read_b64_tr_b16 v[62:63], v181 offset:6656
    ds_read_b64_tr_b16 a[48:49], v184 offset:8192
    v_mov_b32 v170, 0
    v_mfma_f32_32x32x16_bf16 v[80:95], v[140:143], a[120:123], v[80:95]
    ds_read_b64_tr_b16 a[50:51], v184 offset:8704
    ds_read_b64_tr_b16 a[52:53], v185 offset:8192
    ds_read_b64_tr_b16 a[54:55], v185 offset:8704
    v_mov_b32 v171, 0
    v_mfma_f32_32x32x16_bf16 v[80:95], v[18:21], a[128:131], v[80:95]
    buffer_load_dwordx4 v[192:195], v5, s[20:23], s56 offen offset:0 sc1
    ds_read_b64_tr_b16 a[56:57], v184 offset:10240
    ds_read_b64_tr_b16 a[58:59], v184 offset:10752
    v_mov_b32 v172, 0
    v_mfma_f32_32x32x16_bf16 v[80:95], v[26:29], a[136:139], v[80:95]
    ds_read_b64_tr_b16 a[60:61], v185 offset:10240
    ds_read_b64_tr_b16 a[62:63], v185 offset:10752
    ds_read_b64_tr_b16 a[192:193], v10 offset:8192
    v_mov_b32 v173, 0
    s_waitcnt lgkmcnt(15)
    v_mfma_f32_32x32x16_bf16 v[80:95], v[52:55], a[144:147], v[80:95]
    buffer_load_dwordx4 v[196:199], v5, s[20:23], s56 offen offset:1024 sc1
    ds_read_b64_tr_b16 a[194:195], v10 offset:8704
    ds_read_b64_tr_b16 a[196:197], v11 offset:8192
    s_waitcnt lgkmcnt(11)
    v_mfma_f32_32x32x16_bf16 v[80:95], v[60:63], a[152:155], v[80:95]
    ds_read_b64_tr_b16 a[198:199], v11 offset:8704
    ds_read_b64_tr_b16 a[200:201], v10 offset:10240
    ds_read_b64_tr_b16 a[202:203], v10 offset:10752
    v_mov_b32 v174, 0
    v_mfma_f32_32x32x16_bf16 v[96:111], v[128:131], a[116:119], v[96:111]
    buffer_load_dwordx4 v[200:203], v6, s[20:23], s56 offen offset:0 sc1
    ds_read_b64_tr_b16 a[204:205], v11 offset:10240
    ds_read_b64_tr_b16 a[206:207], v11 offset:10752
    v_mov_b32 v175, 0
    v_mfma_f32_32x32x16_bf16 v[96:111], v[136:139], a[124:127], v[96:111]
    ds_read_b64_tr_b16 a[64:65], v184 offset:12288
    ds_read_b64_tr_b16 a[66:67], v184 offset:12800
    ds_read_b64_tr_b16 a[68:69], v185 offset:12288
    v_mfma_f32_32x32x16_bf16 v[96:111], v[14:17], a[132:135], v[96:111]
    buffer_load_dwordx4 v[204:207], v6, s[20:23], s56 offen offset:1024 sc1
    v_mul_f32 v80, v32, v80
    v_mul_f32 v81, v32, v81
    v_mfma_f32_32x32x16_bf16 v[96:111], v[22:25], a[140:143], v[96:111]
    v_mul_f32 v82, v32, v82
    v_mul_f32 v83, v32, v83
    v_mul_f32 v84, v32, v84
    v_mul_f32 v85, v32, v85
    v_mul_f32 v86, v32, v86
    v_mfma_f32_32x32x16_bf16 v[96:111], v[48:51], a[148:151], v[96:111]
    buffer_load_dwordx4 v[240:243], v5, s[20:23], s57 offen offset:0 sc1
    v_mul_f32 v87, v32, v87
    v_mul_f32 v88, v32, v88
    v_mul_f32 v89, v32, v89
    v_mfma_f32_32x32x16_bf16 v[96:111], v[56:59], a[156:159], v[96:111]
    v_mul_f32 v90, v32, v90
    v_mul_f32 v91, v32, v91
    v_mul_f32 v92, v32, v92
    v_mul_f32 v93, v32, v93
    v_mul_f32 v94, v32, v94
    v_mfma_f32_32x32x16_bf16 v[112:127], v[132:135], a[116:119], v[112:127]
    buffer_load_dwordx4 v[244:247], v5, s[20:23], s57 offen offset:1024 sc1
    v_mul_f32 v95, v32, v95
    v_mfma_f32_32x32x16_bf16 v[112:127], v[140:143], a[124:127], v[112:127]
    ds_read_b64_tr_b16 a[70:71], v185 offset:12800
    ds_read_b64_tr_b16 a[72:73], v184 offset:14336
    ds_read_b64_tr_b16 a[74:75], v184 offset:14848
    v_mfma_f32_32x32x16_bf16 v[112:127], v[18:21], a[132:135], v[112:127]
    buffer_load_dwordx4 v[248:251], v6, s[20:23], s57 offen offset:0 sc1
    ds_read_b64_tr_b16 a[76:77], v185 offset:14336
    ds_read_b64_tr_b16 a[78:79], v185 offset:14848
    v_mfma_f32_32x32x16_bf16 v[112:127], v[26:29], a[140:143], v[112:127]
    ds_write_b128 v187, v[96:99] offset:4096
    v_mfma_f32_32x32x16_bf16 v[112:127], v[52:55], a[148:151], v[112:127]
    buffer_load_dwordx4 v[252:255], v6, s[20:23], s57 offen offset:1024 sc1
    ds_read_b64_tr_b16 a[224:225], v10 offset:12288
    ds_read_b64_tr_b16 a[226:227], v10 offset:12800
    v_mfma_f32_32x32x16_bf16 v[112:127], v[60:63], a[156:159], v[112:127]
    ds_write_b128 v187, v[100:103] offset:5120
    v_mfma_f32_32x32x16_bf16 v[64:79], v[128:131], a[112:115], v[64:79]
    buffer_load_dwordx4 v[208:211], v5, s[20:23], s58 offen offset:0 sc1
    ds_read_b64_tr_b16 a[228:229], v11 offset:12288
    ds_read_b64_tr_b16 a[230:231], v11 offset:12800
    v_mfma_f32_32x32x16_bf16 v[64:79], v[136:139], a[120:123], v[64:79]
    ds_write_b128 v187, v[104:107] offset:6144
    v_mfma_f32_32x32x16_bf16 v[64:79], v[14:17], a[128:131], v[64:79]
    buffer_load_dwordx4 v[212:215], v5, s[20:23], s58 offen offset:1024 sc1
    ds_read_b64_tr_b16 a[232:233], v10 offset:14336
    ds_read_b64_tr_b16 a[234:235], v10 offset:14848
    v_mfma_f32_32x32x16_bf16 v[64:79], v[22:25], a[136:139], v[64:79]
    ds_write_b128 v187, v[108:111] offset:7168
    v_mfma_f32_32x32x16_bf16 v[64:79], v[48:51], a[144:147], v[64:79]
    s_waitcnt vmcnt(6)
    v_max3_u32 v45, v192, v193, v194
    v_max3_u32 v46, v195, v196, v197
    v_max3_u32 v45, v198, v199, v45
    v_max3_u32 v46, v200, v201, v46
    v_max3_u32 v45, v202, v203, v45
    v_mfma_f32_32x32x16_bf16 v[64:79], v[56:59], a[152:155], v[64:79]
    v_max3_u32 v46, v204, v205, v46
    v_max3_u32 v45, v206, v207, v45
    v_max_u32 v45, v45, v46
    v_cmp_eq_u32 vcc, -1, v45
    s_cbranch_vccnz L_os0
L_sg0:
    v_mfma_f32_32x32x16_bf16 v[80:95], a[20:23], v[192:195], v[80:95]
    ds_write_b128 v7, v[112:115] offset:4096
    v_mfma_f32_32x32x16_bf16 v[80:95], a[28:31], v[196:199], v[80:95]
    buffer_load_dwordx4 v[216:219], v6, s[20:23], s58 offen offset:0 sc1
    ds_read_b64_tr_b16 a[236:237], v11 offset:14336
    ds_read_b64_tr_b16 a[238:239], v11 offset:14848
    v_mfma_f32_32x32x16_bf16 v[80:95], a[164:167], v[200:203], v[80:95]
    ds_write_b128 v7, v[116:119] offset:5120
    v_mfma_f32_32x32x16_bf16 v[80:95], a[172:175], v[204:207], v[80:95]
    buffer_load_dwordx4 v[220:223], v6, s[20:23], s58 offen offset:1024 sc1
    v_mfma_f32_32x32x16_bf16 v[160:175], a[16:19], v[192:195], v[160:175]
    ds_write_b128 v7, v[120:123] offset:6144
    v_mfma_f32_32x32x16_bf16 v[160:175], a[24:27], v[196:199], v[160:175]
    buffer_load_dwordx4 v[224:227], v5, s[20:23], s59 offen offset:0 sc1
    v_mfma_f32_32x32x16_bf16 v[160:175], a[160:163], v[200:203], v[160:175]
    s_waitcnt vmcnt(5)
    v_max3_u32 v45, v240, v241, v242
    v_max3_u32 v46, v243, v244, v245
    v_max3_u32 v45, v246, v247, v45
    v_max3_u32 v46, v248, v249, v46
    v_max3_u32 v45, v250, v251, v45
    v_mfma_f32_32x32x16_bf16 v[160:175], a[168:171], v[204:207], v[160:175]
    v_max3_u32 v46, v252, v253, v46
    v_max3_u32 v45, v254, v255, v45
    v_max_u32 v45, v45, v46
    v_cmp_eq_u32 vcc, -1, v45
    s_cbranch_vccnz L_os1
L_sg1:
    v_mfma_f32_32x32x16_bf16 v[80:95], a[36:39], v[240:243], v[80:95]
    ds_write_b128 v7, v[124:127] offset:7168
    v_mfma_f32_32x32x16_bf16 v[80:95], a[44:47], v[244:247], v[80:95]
    buffer_load_dwordx4 v[228:231], v5, s[20:23], s59 offen offset:1024 sc1
    v_mfma_f32_32x32x16_bf16 v[80:95], a[180:183], v[248:251], v[80:95]
    buffer_load_dwordx4 v[232:235], v6, s[20:23], s59 offen offset:0 sc1
    v_mfma_f32_32x32x16_bf16 v[80:95], a[188:191], v[252:255], v[80:95]
    buffer_load_dwordx4 v[236:239], v6, s[20:23], s59 offen offset:1024 sc1
    s_waitcnt lgkmcnt(0)
    s_barrier
    ds_read_b128 v[128:131], v189 offset:4096
    ds_read_b128 v[144:147], v190 offset:4096
    v_mfma_f32_32x32x16_bf16 v[160:175], a[32:35], v[240:243], v[160:175]
    ds_read_b128 v[132:135], v189 offset:5120
    ds_read_b128 v[148:151], v190 offset:5120
    v_mfma_f32_32x32x16_bf16 v[160:175], a[40:43], v[244:247], v[160:175]
    ds_read_b128 v[136:139], v189 offset:6144
    ds_read_b128 v[152:155], v190 offset:6144
    v_mfma_f32_32x32x16_bf16 v[160:175], a[176:179], v[248:251], v[160:175]
    s_waitcnt vmcnt(4)
    v_max3_u32 v45, v208, v209, v210
    v_max3_u32 v46, v211, v212, v213
    v_max3_u32 v45, v214, v215, v45
    v_max3_u32 v46, v216, v217, v46
    v_max3_u32 v45, v218, v219, v45
    v_mfma_f32_32x32x16_bf16 v[160:175], a[184:187], v[252:255], v[160:175]
    v_max3_u32 v46, v220, v221, v46
    v_max3_u32 v45, v222, v223, v45
    v_max_u32 v45, v45, v46
    v_cmp_eq_u32 vcc, -1, v45
    s_cbranch_vccnz L_os2
L_sg2:
    v_mfma_f32_32x32x16_bf16 v[80:95], a[52:55], v[208:211], v[80:95]
    ds_read_b128 v[140:143], v189 offset:7168
    ds_read_b128 v[156:159], v190 offset:7168
    v_mfma_f32_32x32x16_bf16 v[80:95], a[60:63], v[212:215], v[80:95]
    v_mfma_f32_32x32x16_bf16 v[80:95], a[196:199], v[216:219], v[80:95]
    s_waitcnt vmcnt(0)
    v_max3_u32 v45, v224, v225, v226
    v_max3_u32 v46, v227, v228, v229
    v_max3_u32 v45, v230, v231, v45
    v_max3_u32 v46, v232, v233, v46
    v_max3_u32 v45, v234, v235, v45
    v_mfma_f32_32x32x16_bf16 v[80:95], a[204:207], v[220:223], v[80:95]
    v_max3_u32 v46, v236, v237, v46
    v_max3_u32 v45, v238, v239, v45
    v_max_u32 v45, v45, v46
    v_cmp_eq_u32 vcc, -1, v45
    s_cbranch_vccnz L_os3
L_sg3:
    v_mfma_f32_32x32x16_bf16 v[80:95], a[68:71], v[224:227], v[80:95]
    s_waitcnt lgkmcnt(6)
    v_add_f32 v128, v128, v144
    v_add_f32 v129, v129, v145
    v_add_f32 v130, v130, v146
    v_add_f32 v131, v131, v147
    v_add_f32 v128, v128, v64
    v_mfma_f32_32x32x16_bf16 v[80:95], a[76:79], v[228:231], v[80:95]
    v_add_f32 v129, v129, v65
    v_add_f32 v130, v130, v66
    v_add_f32 v131, v131, v67
    s_waitcnt lgkmcnt(4)
    v_add_f32 v132, v132, v148
    v_add_f32 v133, v133, v149
    v_mfma_f32_32x32x16_bf16 v[80:95], a[228:231], v[232:235], v[80:95]
    v_add_f32 v134, v134, v150
    v_add_f32 v135, v135, v151
    v_add_f32 v132, v132, v68
    v_add_f32 v133, v133, v69
    v_add_f32 v134, v134, v70
    v_add_f32 v135, v135, v71
    v_mfma_f32_32x32x16_bf16 v[80:95], a[236:239], v[236:239], v[80:95]
    s_waitcnt lgkmcnt(2)
    v_add_f32 v136, v136, v152
    v_add_f32 v137, v137, v153
    v_add_f32 v138, v138, v154
    v_add_f32 v139, v139, v155
    v_add_f32 v136, v136, v72
    s_cmp_lg_u32 s52, 0
    s_cbranch_scc1 L_or
L_odone:
    v_mfma_f32_32x32x16_bf16 v[160:175], a[48:51], v[208:211], v[160:175]
    v_add_f32 v137, v137, v73
    v_add_f32 v138, v138, v74
    v_add_f32 v139, v139, v75
    s_waitcnt lgkmcnt(0)
    v_add_f32 v140, v140, v156
    v_add_f32 v141, v141, v157
    v_mfma_f32_32x32x16_bf16 v[160:175], a[56:59], v[212:215], v[160:175]
    v_add_f32 v142, v142, v158
    v_add_f32 v143, v143, v159
    v_add_f32 v140, v140, v76
    v_add_f32 v141, v141, v77
    v_add_f32 v142, v142, v78
    ds_write_b128 v187, v[80:83] offset:0
    v_mfma_f32_32x32x16_bf16 v[160:175], a[192:195], v[216:219], v[160:175]
    ds_write_b128 v187, v[84:87] offset:1024
    v_mfma_f32_32x32x16_bf16 v[160:175], a[200:203], v[220:223], v[160:175]
    ds_write_b128 v187, v[88:91] offset:2048
    v_mfma_f32_32x32x16_bf16 v[160:175], a[64:67], v[224:227], v[160:175]
    ds_write_b128 v187, v[92:95] offset:3072
    v_mfma_f32_32x32x16_bf16 v[160:175], a[72:75], v[228:231], v[160:175]
    v_add_f32 v143, v143, v79
    s_waitcnt lgkmcnt(0)
    s_barrier
    ds_read_b128 v[96:99], v188 offset:0
    ds_read_b128 v[100:103], v188 offset:1024
    ds_read_b128 v[104:107], v188 offset:2048
    ds_read_b128 v[108:111], v188 offset:3072
    v_mfma_f32_32x32x16_bf16 v[160:175], a[224:227], v[232:235], v[160:175]
    v_mfma_f32_32x32x16_bf16 v[160:175], a[232:235], v[236:239], v[160:175]
    s_waitcnt lgkmcnt(3)
    v_pk_fma_f32 v[128:129], v[128:129], v[32:33], v[96:97] op_sel_hi:[1,0,1]
    v_pk_fma_f32 v[130:131], v[130:131], v[32:33], v[98:99] op_sel_hi:[1,0,1]
    s_waitcnt lgkmcnt(2)
    v_pk_fma_f32 v[132:133], v[132:133], v[32:33], v[100:101] op_sel_hi:[1,0,1]
    v_pk_fma_f32 v[134:135], v[134:135], v[32:33], v[102:103] op_sel_hi:[1,0,1]
    s_waitcnt lgkmcnt(1)
    v_pk_fma_f32 v[136:137], v[136:137], v[32:33], v[104:105] op_sel_hi:[1,0,1]
    v_pk_fma_f32 v[138:139], v[138:139], v[32:33], v[106:107] op_sel_hi:[1,0,1]
    s_waitcnt lgkmcnt(0)
    v_pk_fma_f32 v[140:141], v[140:141], v[32:33], v[108:109] op_sel_hi:[1,0,1]
    v_pk_fma_f32 v[142:143], v[142:143], v[32:33], v[110:111] op_sel_hi:[1,0,1]
    v_pk_add_f32 v[128:129], v[128:129], v[160:161]
    v_pk_add_f32 v[130:131], v[130:131], v[162:163]
    v_cvt_pk_bf16_f32 v80, v128, v129
    v_cvt_pk_bf16_f32 v81, v130, v131
    v_pk_add_f32 v[132:133], v[132:133], v[164:165]
    v_pk_add_f32 v[134:135], v[134:135], v[166:167]
    v_cvt_pk_bf16_f32 v82, v132, v133
    v_cvt_pk_bf16_f32 v83, v134, v135
    buffer_store_dwordx4 v[80:83], v191, s[40:43], s86 offen offset:0
    v_pk_add_f32 v[136:137], v[136:137], v[168:169]
    v_pk_add_f32 v[138:139], v[138:139], v[170:171]
    v_cvt_pk_bf16_f32 v84, v136, v137
    v_cvt_pk_bf16_f32 v85, v138, v139
    v_pk_add_f32 v[140:141], v[140:141], v[172:173]
    v_pk_add_f32 v[142:143], v[142:143], v[174:175]
    v_cvt_pk_bf16_f32 v86, v140, v141
    v_cvt_pk_bf16_f32 v87, v142, v143
    buffer_store_dwordx4 v[84:87], v191, s[40:43], s86 offen offset:32
L_fin:
    s_lshl2_add_u32 s52, s2, s5
    s_cmp_lg_u32 s52, 1020
    s_cbranch_scc1 L_end
    v_lshlrev_b32 v41, 9, v1
    s_mov_b32 s72, 0x40000
    s_mov_b32 s55, 0x1d0000
L_bump:
    buffer_load_dword v44, v41, s[20:23], s55 offen offset:0 sc1
    buffer_load_dword v45, v41, s[20:23], s55 offen offset:128 sc1
    buffer_load_dword v46, v41, s[20:23], s55 offen offset:256 sc1
    buffer_load_dword v47, v41, s[20:23], s55 offen offset:384 sc1
    buffer_load_dword v42, off, s[20:23], 0 sc1
    s_waitcnt vmcnt(0)
    v_xor_b32 v44, v44, v3
    v_xor_b32 v45, v45, v3
    v_xor_b32 v46, v46, v3
    v_xor_b32 v47, v47, v3
    v_or3_b32 v43, v44, v45, v46
    v_or_b32 v43, v43, v47
    v_cmp_ne_u32 vcc, 0, v43
    s_sub_u32 s72, s72, 1
    s_cbranch_scc1 L_end
    s_cbranch_vccnz L_bump
    v_add_u32 v42, 1, v42
    s_mov_b64 exec, 1
    buffer_store_dword v42, off, s[20:23], 0 sc1
L_end:
    s_endpgm
L_hot_end:
L_touch:
    s_branch L_touched
L_idle:
    v_mov_b32 v88, 0x3f803f80
    v_mov_b32 v89, 0x3f803f80
    v_mov_b32 v90, 0x3f803f80
    v_mov_b32 v91, 0x3f803f80
    v_lshrrev_b32 v96, 2, v1
    v_and_b32 v97, 3, v1
    v_lshlrev_b32 v96, 17, v96
    v_lshl_add_u32 v96, v97, 9, v96
    s_and_b32 s52, s7, 8
    s_lshl_b32 s53, s52, 17
    s_lshl_b32 s54, s69, 11
    s_add_u32 s53, s53, s54
    s_add_u32 s53, s53, 0x220000
    s_mov_b32 exec_hi, 0
    buffer_store_dwordx4 v[88:91], v96, s[20:23], s53 offen offset:448 sc1
    s_mov_b32 exec_hi, -1
    s_add_u32 m0, s51, 16384
    s_lshl_b32 s52, s60, 7
    s_add_u32 s52, s52, s48
    buffer_load_dwordx4 v5, s[8:11], s52 offen offset:0  lds
    buffer_load_dwordx4 v6, s[8:11], s52 offen offset:1024  lds
    buffer_load_dwordx4 v7, s[8:11], s52 offen offset:2048  lds
    buffer_load_dwordx4 v8, s[8:11], s52 offen offset:3072  lds
    s_add_u32 s60, s60, 1
    s_cmp_eq_u32 s60, 7
    s_cselect_b32 s60, 0, s60
    s_add_u32 m0, s51, 32768
    s_lshl_b32 s52, s60, 7
    s_add_u32 s52, s52, s48
    buffer_load_dwordx4 v5, s[8:11], s52 offen offset:0  lds
    buffer_load_dwordx4 v6, s[8:11], s52 offen offset:1024  lds
    buffer_load_dwordx4 v7, s[8:11], s52 offen offset:2048  lds
    buffer_load_dwordx4 v8, s[8:11], s52 offen offset:3072  lds
    s_add_u32 s60, s60, 1
    s_cmp_eq_u32 s60, 7
    s_cselect_b32 s60, 0, s60
    s_add_u32 m0, s51, 49152
    s_lshl_b32 s52, s60, 7
    s_add_u32 s52, s52, s48
    buffer_load_dwordx4 v5, s[8:11], s52 offen offset:0  lds
    buffer_load_dwordx4 v6, s[8:11], s52 offen offset:1024  lds
    buffer_load_dwordx4 v7, s[8:11], s52 offen offset:2048  lds
    buffer_load_dwordx4 v8, s[8:11], s52 offen offset:3072  lds
    s_add_u32 s60, s60, 1
    s_cmp_eq_u32 s60, 7
    s_cselect_b32 s60, 0, s60
    s_waitcnt vmcnt(12)
    s_mov_b32 s44, 0x9e3779b1
    v_mul_lo_u32 v3, s44, v3
    v_xor_b32 v3, 0x5bd1e995, v3
    s_mov_b32 s53, 0x1d0000
    s_barrier
    buffer_store_dword v3, v4, s[20:23], s53 offen sc1
    s_add_u32 m0, s51, 65536
    s_lshl_b32 s52, s60, 7
    s_add_u32 s52, s52, s48
    buffer_load_dwordx4 v5, s[8:11], s52 offen offset:0  lds
    buffer_load_dwordx4 v6, s[8:11], s52 offen offset:1024  lds
    buffer_load_dwordx4 v7, s[8:11], s52 offen offset:2048  lds
    buffer_load_dwordx4 v8, s[8:11], s52 offen offset:3072  lds
    s_add_u32 s60, s60, 1
    s_cmp_eq_u32 s60, 7
    s_cselect_b32 s60, 0, s60
    s_add_u32 m0, s51, 81920
    s_lshl_b32 s52, s60, 7
    s_add_u32 s52, s52, s48
    buffer_load_dwordx4 v5, s[8:11], s52 offen offset:0  lds
    buffer_load_dwordx4 v6, s[8:11], s52 offen offset:1024  lds
    buffer_load_dwordx4 v7, s[8:11], s52 offen offset:2048  lds
    buffer_load_dwordx4 v8, s[8:11], s52 offen offset:3072  lds
    s_add_u32 s60, s60, 1
    s_cmp_eq_u32 s60, 7
    s_cselect_b32 s60, 0, s60
    s_add_u32 m0, s51, 98304
    s_lshl_b32 s52, s60, 7
    s_add_u32 s52, s52, s48
    buffer_load_dwordx4 v5, s[8:11], s52 offen offset:0  lds
    buffer_load_dwordx4 v6, s[8:11], s52 offen offset:1024  lds
    buffer_load_dwordx4 v7, s[8:11], s52 offen offset:2048  lds
    buffer_load_dwordx4 v8, s[8:11], s52 offen offset:3072  lds
    s_add_u32 s60, s60, 1
    s_cmp_eq_u32 s60, 7
    s_cselect_b32 s60, 0, s60
    s_lshr_b32 s52, s51, 2
    s_add_u32 m0, s52, 131072
    s_mul_i32 s53, s89, 172032
    s_add_u32 s53, s53, s88
    buffer_load_dwordx4 v13, s[12:15], s53 offen  lds
    s_add_u32 s89, s89, 1
    s_cmp_eq_u32 s89, 7
    s_cselect_b32 s89, 0, s89
    s_lshr_b32 s52, s51, 2
    s_add_u32 m0, s52, 135168
    s_mul_i32 s53, s89, 172032
    s_add_u32 s53, s53, s88
    buffer_load_dwordx4 v13, s[12:15], s53 offen  lds
    s_add_u32 s89, s89, 1
    s_cmp_eq_u32 s89, 7
    s_cselect_b32 s89, 0, s89
    s_lshr_b32 s52, s51, 2
    s_add_u32 m0, s52, 139264
    s_mul_i32 s53, s89, 172032
    s_add_u32 s53, s53, s88
    buffer_load_dwordx4 v13, s[12:15], s53 offen  lds
    s_add_u32 s89, s89, 1
    s_cmp_eq_u32 s89, 7
    s_cselect_b32 s89, 0, s89
    s_lshr_b32 s52, s51, 2
    s_add_u32 m0, s52, 143360
    s_mul_i32 s53, s89, 172032
    s_add_u32 s53, s53, s88
    buffer_load_dwordx4 v13, s[12:15], s53 offen  lds
    s_add_u32 s89, s89, 1
    s_cmp_eq_u32 s89, 7
    s_cselect_b32 s89, 0, s89
    s_lshr_b32 s52, s51, 2
    s_add_u32 m0, s52, 147456
    s_mul_i32 s53, s89, 172032
    s_add_u32 s53, s53, s88
    buffer_load_dwordx4 v13, s[12:15], s53 offen  lds
    s_add_u32 s89, s89, 1
    s_cmp_eq_u32 s89, 7
    s_cselect_b32 s89, 0, s89
    s_lshr_b32 s52, s51, 2
    s_add_u32 m0, s52, 151552
    s_mul_i32 s53, s89, 172032
    s_add_u32 s53, s53, s88
    buffer_load_dwordx4 v13, s[12:15], s53 offen  lds
    s_add_u32 s89, s89, 1
    s_cmp_eq_u32 s89, 7
    s_cselect_b32 s89, 0, s89
    s_lshr_b32 s52, s51, 2
    s_add_u32 m0, s52, 155648
    s_mul_i32 s53, s89, 172032
    s_add_u32 s53, s53, s88
    buffer_load_dwordx4 v13, s[12:15], s53 offen  lds
    s_add_u32 s89, s89, 1
    s_cmp_eq_u32 s89, 7
    s_cselect_b32 s89, 0, s89
    s_waitcnt vmcnt(0) lgkmcnt(0)
    s_mov_b32 s56, 0x40000000
    s_mov_b32 s57, 0x40000000
    s_mov_b32 s58, 0x40000000
    s_mov_b32 s59, 0x40000000
    s_mov_b32 s83, 0x40000000
    v_mov_b32 v24, v2
    ds_read_b128 a[0:3], v14 offset:0
    ds_read_b128 a[8:11], v15 offset:0
    ds_read_b128 a[16:19], v16 offset:0
    ds_read_b128 a[24:27], v17 offset:0
    ds_read_b128 a[32:35], v14 offset:16384
    ds_read_b128 a[40:43], v15 offset:16384
    ds_read_b128 a[48:51], v16 offset:16384
    ds_read_b128 a[56:59], v17 offset:16384
    ds_read_b128 a[64:67], v14 offset:32768
    ds_read_b128 a[72:75], v15 offset:32768
    ds_read_b128 a[80:83], v16 offset:32768
    ds_read_b128 a[88:91], v17 offset:32768
    ds_read_b128 a[96:99], v14 offset:49152
    ds_read_b128 a[104:107], v15 offset:49152
    ds_read_b128 a[112:115], v16 offset:49152
    ds_read_b128 a[120:123], v17 offset:49152
    v_add_u32 v14, 0x10000, v14
    v_add_u32 v15, 0x10000, v15
    v_add_u32 v16, 0x10000, v16
    v_add_u32 v17, 0x10000, v17
    ds_read_b128 a[128:131], v14 offset:0
    ds_read_b128 a[136:139], v15 offset:0
    ds_read_b128 a[144:147], v16 offset:0
    ds_read_b128 a[152:155], v17 offset:0
    ds_read_b128 a[160:163], v14 offset:16384
    ds_read_b128 a[168:171], v15 offset:16384
    ds_read_b128 a[176:179], v16 offset:16384
    ds_read_b128 a[184:187], v17 offset:16384
    ds_read_b128 a[192:195], v14 offset:32768
    ds_read_b128 a[200:203], v15 offset:32768
    ds_read_b128 a[208:211], v16 offset:32768
    ds_read_b128 a[216:219], v17 offset:32768
    ds_write_b16 v25, v27
    ds_write_b16 v26, v28
    s_waitcnt vmcnt(0) lgkmcnt(0)
    s_barrier
    s_lshl2_add_u32 s54, s2, s5
    v_lshlrev_b32 v47, 7, v1
    s_lshl_b32 s54, s54, 9
    v_min_u32 v47, 384, v47
    buffer_load_dword v9, v47, s[32:35], s54 offen
    ds_read_b64_tr_b16 v[64:65], v23 offset:0
    ds_read_b64_tr_b16 v[66:67], v23 offset:256
    ds_read_b64_tr_b16 v[68:69], v23 offset:1024
    ds_read_b64_tr_b16 v[70:71], v23 offset:1280
    ds_read_b64_tr_b16 v[72:73], v23 offset:2048
    ds_read_b64_tr_b16 v[74:75], v23 offset:2304
    s_waitcnt lgkmcnt(4)
    v_mfma_f32_32x32x16_bf16 v[208:223], v[64:67], a[0:3], 0
    ds_read_b64_tr_b16 v[76:77], v23 offset:3072
    ds_read_b64_tr_b16 v[78:79], v23 offset:3328
    s_add_u32 m0, s71, 0
    s_nop 0
    buffer_load_dwordx4 v176, s[28:31], s70 offen offset:0  lds
    s_waitcnt lgkmcnt(4)
    v_mfma_f32_32x32x16_bf16 v[208:223], v[68:71], a[8:11], v[208:223]
    ds_read_b64_tr_b16 v[64:65], v23 offset:4096
    ds_read_b64_tr_b16 v[66:67], v23 offset:4352
    buffer_load_dwordx4 v177, s[28:31], s70 offen offset:1024  lds
    s_waitcnt lgkmcnt(4)
    v_mfma_f32_32x32x16_bf16 v[208:223], v[72:75], a[16:19], v[208:223]
    ds_read_b64_tr_b16 v[68:69], v23 offset:5120
    ds_read_b64_tr_b16 v[70:71], v23 offset:5376
    buffer_load_dwordx4 v178, s[28:31], s70 offen offset:2048  lds
    s_waitcnt lgkmcnt(4)
    v_mfma_f32_32x32x16_bf16 v[208:223], v[76:79], a[24:27], v[208:223]
    ds_read_b64_tr_b16 v[72:73], v23 offset:6144
    ds_read_b64_tr_b16 v[74:75], v23 offset:6400
    buffer_load_dwordx4 v179, s[28:31], s70 offen offset:3072  lds
    s_add_u32 s70, s70, 28672
    s_waitcnt lgkmcnt(4)
    v_mfma_f32_32x32x16_bf16 v[208:223], v[64:67], a[32:35], v[208:223]
    ds_read_b64_tr_b16 v[76:77], v23 offset:7168
    ds_read_b64_tr_b16 v[78:79], v23 offset:7424
    s_add_u32 m0, s71, 4096
    s_nop 0
    buffer_load_dwordx4 v176, s[28:31], s70 offen offset:0  lds
    s_waitcnt lgkmcnt(4)
    v_mfma_f32_32x32x16_bf16 v[208:223], v[68:71], a[40:43], v[208:223]
    ds_read_b64_tr_b16 v[64:65], v23 offset:8192
    ds_read_b64_tr_b16 v[66:67], v23 offset:8448
    buffer_load_dwordx4 v177, s[28:31], s70 offen offset:1024  lds
    s_waitcnt lgkmcnt(4)
    v_mfma_f32_32x32x16_bf16 v[208:223], v[72:75], a[48:51], v[208:223]
    ds_read_b64_tr_b16 v[68:69], v23 offset:9216
    ds_read_b64_tr_b16 v[70:71], v23 offset:9472
    buffer_load_dwordx4 v178, s[28:31], s70 offen offset:2048  lds
    s_waitcnt lgkmcnt(4)
    v_mfma_f32_32x32x16_bf16 v[208:223], v[76:79], a[56:59], v[208:223]
    ds_read_b64_tr_b16 v[72:73], v23 offset:10240
    ds_read_b64_tr_b16 v[74:75], v23 offset:10496
    buffer_load_dwordx4 v179, s[28:31], s70 offen offset:3072  lds
    s_add_u32 s70, s70, 28672
    s_cmp_eq_u32 s70, s84
    s_cselect_b32 s70, s79, s70
    s_waitcnt lgkmcnt(4)
    v_mfma_f32_32x32x16_bf16 v[208:223], v[64:67], a[64:67], v[208:223]
    ds_read_b64_tr_b16 v[76:77], v23 offset:11264
    ds_read_b64_tr_b16 v[78:79], v23 offset:11520
    s_add_u32 m0, s71, 8192
    s_nop 0
    buffer_load_dwordx4 v176, s[28:31], s70 offen offset:0  lds
    s_waitcnt lgkmcnt(4)
    v_mfma_f32_32x32x16_bf16 v[208:223], v[68:71], a[72:75], v[208:223]
    ds_read_b64_tr_b16 v[64:65], v23 offset:12288
    ds_read_b64_tr_b16 v[66:67], v23 offset:12544
    buffer_load_dwordx4 v177, s[28:31], s70 offen offset:1024  lds
    s_waitcnt lgkmcnt(4)
    v_mfma_f32_32x32x16_bf16 v[208:223], v[72:75], a[80:83], v[208:223]
    ds_read_b64_tr_b16 v[68:69], v23 offset:13312
    ds_read_b64_tr_b16 v[70:71], v23 offset:13568
    buffer_load_dwordx4 v178, s[28:31], s70 offen offset:2048  lds
    s_waitcnt lgkmcnt(4)
    v_mfma_f32_32x32x16_bf16 v[208:223], v[76:79], a[88:91], v[208:223]
    ds_read_b64_tr_b16 v[72:73], v23 offset:14336
    ds_read_b64_tr_b16 v[74:75], v23 offset:14592
    buffer_load_dwordx4 v179, s[28:31], s70 offen offset:3072  lds
    s_add_u32 s70, s70, 28672
    s_waitcnt lgkmcnt(4)
    v_mfma_f32_32x32x16_bf16 v[208:223], v[64:67], a[96:99], v[208:223]
    ds_read_b64_tr_b16 v[76:77], v23 offset:15360
    ds_read_b64_tr_b16 v[78:79], v23 offset:15616
    s_add_u32 m0, s71, 12288
    s_nop 0
    buffer_load_dwordx4 v176, s[28:31], s70 offen offset:0  lds
    s_waitcnt lgkmcnt(4)
    v_mfma_f32_32x32x16_bf16 v[208:223], v[68:71], a[104:107], v[208:223]
    ds_read_b64_tr_b16 v[64:65], v23 offset:16384
    ds_read_b64_tr_b16 v[66:67], v23 offset:16640
    buffer_load_dwordx4 v177, s[28:31], s70 offen offset:1024  lds
    s_waitcnt lgkmcnt(4)
    v_mfma_f32_32x32x16_bf16 v[208:223], v[72:75], a[112:115], v[208:223]
    ds_read_b64_tr_b16 v[68:69], v23 offset:17408
    ds_read_b64_tr_b16 v[70:71], v23 offset:17664
    buffer_load_dwordx4 v178, s[28:31], s70 offen offset:2048  lds
    s_waitcnt lgkmcnt(4)
    v_mfma_f32_32x32x16_bf16 v[208:223], v[76:79], a[120:123], v[208:223]
    ds_read_b64_tr_b16 v[72:73], v23 offset:18432
    ds_read_b64_tr_b16 v[74:75], v23 offset:18688
    buffer_load_dwordx4 v179, s[28:31], s70 offen offset:3072  lds
    s_add_u32 s70, s70, 28672
    s_cmp_eq_u32 s70, s84
    s_cselect_b32 s70, s79, s70
    s_waitcnt lgkmcnt(4)
    v_mfma_f32_32x32x16_bf16 v[208:223], v[64:67], a[128:131], v[208:223]
    ds_read_b64_tr_b16 v[76:77], v23 offset:19456
    ds_read_b64_tr_b16 v[78:79], v23 offset:19712
    s_and_b32 s44, s4, 1
    s_waitcnt lgkmcnt(4)
    v_mfma_f32_32x32x16_bf16 v[208:223], v[68:71], a[136:139], v[208:223]
    ds_read_b64_tr_b16 v[64:65], v23 offset:20480
    ds_read_b64_tr_b16 v[66:67], v23 offset:20736
    s_lshl1_add_u32 s48, s69, s44
    s_waitcnt lgkmcnt(4)
    v_mfma_f32_32x32x16_bf16 v[208:223], v[72:75], a[144:147], v[208:223]
    ds_read_b64_tr_b16 v[68:69], v23 offset:21504
    ds_read_b64_tr_b16 v[70:71], v23 offset:21760
    s_lshr_b32 s44, s4, 1
    s_waitcnt lgkmcnt(4)
    v_mfma_f32_32x32x16_bf16 v[208:223], v[76:79], a[152:155], v[208:223]
    ds_read_b64_tr_b16 v[72:73], v23 offset:22528
    ds_read_b64_tr_b16 v[74:75], v23 offset:22784
    s_lshl3_add_u32 s48, s48, s44
    s_waitcnt lgkmcnt(4)
    v_mfma_f32_32x32x16_bf16 v[208:223], v[64:67], a[160:163], v[208:223]
    ds_read_b64_tr_b16 v[76:77], v23 offset:23552
    ds_read_b64_tr_b16 v[78:79], v23 offset:23808
    s_lshl_b32 s48, s48, 7
    s_waitcnt lgkmcnt(4)
    v_mfma_f32_32x32x16_bf16 v[208:223], v[68:71], a[168:171], v[208:223]
    ds_read_b64_tr_b16 v[64:65], v23 offset:24576
    ds_read_b64_tr_b16 v[66:67], v23 offset:24832
    s_add_u32 s48, s48, 0x1e0000
    s_waitcnt lgkmcnt(4)
    v_mfma_f32_32x32x16_bf16 v[208:223], v[72:75], a[176:179], v[208:223]
    ds_read_b64_tr_b16 v[68:69], v23 offset:25600
    ds_read_b64_tr_b16 v[70:71], v23 offset:25856
    s_lshr_b32 s49, s85, 1
    s_waitcnt lgkmcnt(4)
    v_mfma_f32_32x32x16_bf16 v[208:223], v[76:79], a[184:187], v[208:223]
    ds_read_b64_tr_b16 v[72:73], v23 offset:26624
    ds_read_b64_tr_b16 v[74:75], v23 offset:26880
    s_lshl2_add_u32 s49, s49, s5
    s_waitcnt lgkmcnt(4)
    v_mfma_f32_32x32x16_bf16 v[208:223], v[64:67], a[192:195], v[208:223]
    ds_read_b64_tr_b16 v[76:77], v23 offset:27648
    ds_read_b64_tr_b16 v[78:79], v23 offset:27904
    s_lshl_b32 s49, s49, 10
    s_waitcnt lgkmcnt(4)
    v_mfma_f32_32x32x16_bf16 v[208:223], v[68:71], a[200:203], v[208:223]
    s_add_u32 s49, s49, 0x1e0000
    s_waitcnt lgkmcnt(2)
    v_mfma_f32_32x32x16_bf16 v[208:223], v[72:75], a[208:211], v[208:223]
    s_lshl4_add_u32 s44, s85, s5
    s_waitcnt lgkmcnt(0)
    v_mfma_f32_32x32x16_bf16 v[208:223], v[76:79], a[216:219], v[208:223]
    s_lshl_b32 s44, s44, 11
    v_add_u32 v5, s44, v2
    v_xor_b32 v6, 0x1000, v5
    v_xor_b32 v7, 24576, v190
    v_mov_b32 v14, -1
    v_mov_b32 v15, -1
    v_mov_b32 v16, -1
    v_mov_b32 v17, -1
    s_add_u32 s66, s66, 0x4001c000
    s_add_u32 s67, s67, 0x40002000
    s_lshl_b32 s55, s5, 13
    s_add_u32 s55, s55, 0x1d0000
    s_mov_b32 s90, 0x40000000
    s_cmp_eq_u32 s62, 0
    s_cselect_b64 vcc, -1, 0
    v_mov_b32 v41, v208
    v_mov_b32 v42, v208
    v_mov_b32 v43, v220
    v_mov_b32 v44, v220
    v_mul_f32 v208, 0x3e8b97f6, v208
    v_mul_f32 v209, 0x3e8b97f6, v209
    v_mul_f32 v210, 0x3e8b97f6, v210
    v_mul_f32 v211, 0x3e8b97f6, v211
    v_mul_f32 v212, 0x3e8b97f6, v212
    v_mul_f32 v213, 0x3e8b97f6, v213
    v_mul_f32 v214, 0x3e8b97f6, v214
    v_mul_f32 v215, 0x3e8b97f6, v215
    v_mul_f32 v216, 0x3e8b97f6, v216
    v_mul_f32 v217, 0x3e8b97f6, v217
    v_mul_f32 v218, 0x3e8b97f6, v218
    v_mul_f32 v219, 0x3e8b97f6, v219
    v_mul_f32 v220, 0x3e8b97f6, v220
    v_mul_f32 v221, 0x3e8b97f6, v221
    v_mul_f32 v222, 0x3e8b97f6, v222
    v_mul_f32 v223, 0x3e8b97f6, v223
    v_permlane32_swap_b32 v41, v42
    v_permlane32_swap_b32 v43, v44
    v_cvt_pk_bf16_f32 v208, v208, v209
    v_cvt_pk_bf16_f32 v209, v210, v211
    v_cvt_pk_bf16_f32 v210, v212, v213
    v_cvt_pk_bf16_f32 v211, v214, v215
    v_cvt_pk_bf16_f32 v212, v216, v217
    v_cvt_pk_bf16_f32 v213, v218, v219
    v_cvt_pk_bf16_f32 v214, v220, v221
    v_cvt_pk_bf16_f32 v215, v222, v223
    v_cndmask_b32 v41, v41, v44, vcc
    v_and_b32 v208, v29, v208
    v_and_b32 v209, v29, v209
    v_and_b32 v214, v30, v214
    v_and_b32 v215, v30, v215
    ds_write_b128 v39, v[208:211] offset:0
    ds_write_b128 v39, v[212:215] offset:1024
    v_mul_f32 v41, 0xbfb8aa3b, v41
    v_exp_f32 v41, v41
    v_accvgpr_write_b32 a224, v208
    v_accvgpr_write_b32 a225, v209
    v_accvgpr_write_b32 a226, v210
    v_accvgpr_write_b32 a227, v211
    v_accvgpr_write_b32 a228, v212
    v_accvgpr_write_b32 a229, v213
    v_accvgpr_write_b32 a230, v214
    v_accvgpr_write_b32 a231, v215
    v_add_f32 v43, 1.0, v41
    v_rcp_f32 v31, v43
    v_xor_b32 v44, 2048, v39
    v_xor_b32 v45, 4096, v39
    v_xor_b32 v46, 6144, v39
    v_sub_f32 v43, 1.0, v31
    s_waitcnt lgkmcnt(0)
    s_barrier
    ds_read_b128 a[232:235], v44 offset:0
    ds_read_b128 a[236:239], v44 offset:1024
    ds_read_b128 a[240:243], v45 offset:0
    ds_read_b128 a[244:247], v45 offset:1024
    ds_read_b128 a[248:251], v46 offset:0
    ds_read_b128 a[252:255], v46 offset:1024
    s_waitcnt lgkmcnt(0)
    s_branch L_kvslow
L_kvslow:
    s_mov_b32 s72, 0x20000
    s_mov_b64 exec, s[64:65]
L_pk:
    buffer_load_dword v35, v34, s[20:23], s55 offen sc1
    s_waitcnt vmcnt(0)
    v_cmp_ne_u32 vcc, v35, v3
    s_sub_u32 s72, s72, 1
    s_cbranch_scc1 L_pk_ok
    s_and_b64 vcc, vcc, exec
    s_cbranch_scc0 L_pk_ok
    s_mov_b64 exec, vcc
    s_branch L_pk
L_pk_ok:
    s_mov_b64 exec, -1
    s_sub_u32 s66, s66, 0x4001c000
    s_sub_u32 s67, s67, 0x40002000
    buffer_load_dwordx4 a[0:3], v2, s[20:23], s66 offen offset:0 sc1
    buffer_load_dwordx4 a[4:7], v2, s[20:23], s66 offen offset:1024 sc1
    buffer_load_dwordx4 a[8:11], v36, s[20:23], s67 offen offset:0 sc1
    buffer_load_dwordx4 a[12:15], v36, s[20:23], s67 offen offset:1024 sc1
    s_add_u32 s66, s66, 28672
    s_add_u32 s67, s67, 2048
    buffer_load_dwordx4 a[16:19], v2, s[20:23], s66 offen offset:0 sc1
    buffer_load_dwordx4 a[20:23], v2, s[20:23], s66 offen offset:1024 sc1
    buffer_load_dwordx4 a[24:27], v36, s[20:23], s67 offen offset:0 sc1
    buffer_load_dwordx4 a[28:31], v36, s[20:23], s67 offen offset:1024 sc1
    s_add_u32 s66, s66, 28672
    s_add_u32 s67, s67, 2048
    s_cmp_eq_u32 s67, s76
    s_cselect_b32 s66, s74, s66
    s_cselect_b32 s67, s75, s67
    buffer_load_dwordx4 a[32:35], v2, s[20:23], s66 offen offset:0 sc1
    buffer_load_dwordx4 a[36:39], v2, s[20:23], s66 offen offset:1024 sc1
    buffer_load_dwordx4 a[40:43], v36, s[20:23], s67 offen offset:0 sc1
    buffer_load_dwordx4 a[44:47], v36, s[20:23], s67 offen offset:1024 sc1
    s_add_u32 s66, s66, 28672
    s_add_u32 s67, s67, 2048
    buffer_load_dwordx4 a[48:51], v2, s[20:23], s66 offen offset:0 sc1
    buffer_load_dwordx4 a[52:55], v2, s[20:23], s66 offen offset:1024 sc1
    buffer_load_dwordx4 a[56:59], v36, s[20:23], s67 offen offset:0 sc1
    buffer_load_dwordx4 a[60:63], v36, s[20:23], s67 offen offset:1024 sc1
    s_add_u32 s66, s66, 28672
    s_add_u32 s67, s67, 2048
    s_cmp_eq_u32 s67, s76
    s_cselect_b32 s66, s74, s66
    s_cselect_b32 s67, s75, s67
    s_branch L_kvback
L_hslow:
    s_mov_b32 s72, 0x20000
    s_mov_b64 exec, 0x7f7f
L_ph:
    buffer_load_dword v35, v38, s[20:23], s55 offen sc1
    s_waitcnt vmcnt(0)
    v_cmp_ne_u32 vcc, v35, v3
    s_sub_u32 s72, s72, 1
    s_cbranch_scc1 L_ph_ok
    s_and_b64 vcc, vcc, exec
    s_cbranch_scc0 L_ph_ok
    s_mov_b64 exec, vcc
    s_branch L_ph
L_ph_ok:
    s_mov_b64 exec, -1
    s_branch L_hback
L_pslow:
    s_mov_b32 s55, s49
    s_mov_b32 s72, 0x20000
    s_mov_b64 exec, 0xff
L_pp:
    buffer_load_dword v35, v38, s[20:23], s55 offen sc1
    s_waitcnt vmcnt(0)
    v_cmp_ne_u32 vcc, v35, v3
    s_sub_u32 s72, s72, 1
    s_cbranch_scc1 L_pp_ok
    s_and_b64 vcc, vcc, exec
    s_cbranch_scc0 L_pp_ok
    s_mov_b64 exec, vcc
    s_branch L_pp
L_pp_ok:
    s_mov_b64 exec, -1
    s_branch L_pback
L_os0:
    buffer_load_dwordx4 v[192:195], v5, s[20:23], s56 offen offset:0 sc1
    buffer_load_dwordx4 v[196:199], v5, s[20:23], s56 offen offset:1024 sc1
    buffer_load_dwordx4 v[200:203], v6, s[20:23], s56 offen offset:0 sc1
    buffer_load_dwordx4 v[204:207], v6, s[20:23], s56 offen offset:1024 sc1
    s_bitset1_b32 s52, 0
    s_nop 6
    s_waitcnt lgkmcnt(0)
    ds_write_b128 v7, v[112:115] offset:4096
    buffer_load_dwordx4 v[216:219], v6, s[20:23], s58 offen offset:0 sc1
    ds_read_b64_tr_b16 a[236:237], v11 offset:14336
    ds_read_b64_tr_b16 a[238:239], v11 offset:14848
    ds_write_b128 v7, v[116:119] offset:5120
    buffer_load_dwordx4 v[220:223], v6, s[20:23], s58 offen offset:1024 sc1
    ds_write_b128 v7, v[120:123] offset:6144
    buffer_load_dwordx4 v[224:227], v5, s[20:23], s59 offen offset:0 sc1
    s_waitcnt vmcnt(9)
    v_max3_u32 v45, v240, v241, v242
    v_max3_u32 v46, v243, v244, v245
    v_max3_u32 v45, v246, v247, v45
    v_max3_u32 v46, v248, v249, v46
    v_max3_u32 v45, v250, v251, v45
    v_max3_u32 v46, v252, v253, v46
    v_max3_u32 v45, v254, v255, v45
    v_max_u32 v45, v45, v46
    v_cmp_eq_u32 vcc, -1, v45
    s_cbranch_vccnz L_os1
    s_branch L_sg1
L_os1:
    buffer_load_dwordx4 v[240:243], v5, s[20:23], s57 offen offset:0 sc1
    buffer_load_dwordx4 v[244:247], v5, s[20:23], s57 offen offset:1024 sc1
    buffer_load_dwordx4 v[248:251], v6, s[20:23], s57 offen offset:0 sc1
    buffer_load_dwordx4 v[252:255], v6, s[20:23], s57 offen offset:1024 sc1
    s_bitset1_b32 s52, 1
    s_nop 6
    s_waitcnt lgkmcnt(0)
    ds_write_b128 v7, v[124:127] offset:7168
    buffer_load_dwordx4 v[228:231], v5, s[20:23], s59 offen offset:1024 sc1
    buffer_load_dwordx4 v[232:235], v6, s[20:23], s59 offen offset:0 sc1
    buffer_load_dwordx4 v[236:239], v6, s[20:23], s59 offen offset:1024 sc1
    s_waitcnt lgkmcnt(0)
    s_barrier
    ds_read_b128 v[128:131], v189 offset:4096
    ds_read_b128 v[144:147], v190 offset:4096
    ds_read_b128 v[132:135], v189 offset:5120
    ds_read_b128 v[148:151], v190 offset:5120
    ds_read_b128 v[136:139], v189 offset:6144
    ds_read_b128 v[152:155], v190 offset:6144
    s_waitcnt vmcnt(8)
    v_max3_u32 v45, v208, v209, v210
    v_max3_u32 v46, v211, v212, v213
    v_max3_u32 v45, v214, v215, v45
    v_max3_u32 v46, v216, v217, v46
    v_max3_u32 v45, v218, v219, v45
    v_max3_u32 v46, v220, v221, v46
    v_max3_u32 v45, v222, v223, v45
    v_max_u32 v45, v45, v46
    v_cmp_eq_u32 vcc, -1, v45
    s_cbranch_vccnz L_os2
    s_branch L_sg2
L_os2:
    buffer_load_dwordx4 v[208:211], v5, s[20:23], s58 offen offset:0 sc1
    buffer_load_dwordx4 v[212:215], v5, s[20:23], s58 offen offset:1024 sc1
    buffer_load_dwordx4 v[216:219], v6, s[20:23], s58 offen offset:0 sc1
    buffer_load_dwordx4 v[220:223], v6, s[20:23], s58 offen offset:1024 sc1
    s_bitset1_b32 s52, 2
    s_nop 6
    s_waitcnt lgkmcnt(0)
    ds_read_b128 v[140:143], v189 offset:7168
    ds_read_b128 v[156:159], v190 offset:7168
    s_waitcnt vmcnt(4)
    v_max3_u32 v45, v224, v225, v226
    v_max3_u32 v46, v227, v228, v229
    v_max3_u32 v45, v230, v231, v45
    v_max3_u32 v46, v232, v233, v46
    v_max3_u32 v45, v234, v235, v45
    v_max3_u32 v46, v236, v237, v46
    v_max3_u32 v45, v238, v239, v45
    v_max_u32 v45, v45, v46
    v_cmp_eq_u32 vcc, -1, v45
    s_cbranch_vccnz L_os3
    s_branch L_sg3
L_os3:
    buffer_load_dwordx4 v[224:227], v5, s[20:23], s59 offen offset:0 sc1
    buffer_load_dwordx4 v[228:231], v5, s[20:23], s59 offen offset:1024 sc1
    buffer_load_dwordx4 v[232:235], v6, s[20:23], s59 offen offset:0 sc1
    buffer_load_dwordx4 v[236:239], v6, s[20:23], s59 offen offset:1024 sc1
    s_bitset1_b32 s52, 3
    s_nop 6
    s_waitcnt lgkmcnt(0)
    s_waitcnt lgkmcnt(0)
    v_add_f32 v128, v128, v144
    v_add_f32 v129, v129, v145
    v_add_f32 v130, v130, v146
    v_add_f32 v131, v131, v147
    v_add_f32 v128, v128, v64
    v_add_f32 v129, v129, v65
    v_add_f32 v130, v130, v66
    v_add_f32 v131, v131, v67
    s_waitcnt lgkmcnt(0)
    v_add_f32 v132, v132, v148
    v_add_f32 v133, v133, v149
    v_add_f32 v134, v134, v150
    v_add_f32 v135, v135, v151
    v_add_f32 v132, v132, v68
    v_add_f32 v133, v133, v69
    v_add_f32 v134, v134, v70
    v_add_f32 v135, v135, v71
    s_waitcnt lgkmcnt(0)
    v_add_f32 v136, v136, v152
    v_add_f32 v137, v137, v153
    v_add_f32 v138, v138, v154
    v_add_f32 v139, v139, v155
    v_add_f32 v136, v136, v72
L_or:
    s_waitcnt vmcnt(0) lgkmcnt(0)
L_orb:
    s_bitcmp1_b32 s52, 0
    s_cbranch_scc0 L_or0
    v_max3_u32 v45, v192, v193, v194
    v_max3_u32 v46, v195, v196, v197
    v_max3_u32 v45, v198, v199, v45
    v_max3_u32 v46, v200, v201, v46
    v_max3_u32 v45, v202, v203, v45
    v_max3_u32 v46, v204, v205, v46
    v_max3_u32 v45, v206, v207, v45
    v_max_u32 v45, v45, v46
    v_cmp_eq_u32 vcc, -1, v45
    s_cbranch_vccz L_og0
    buffer_load_dwordx4 v[192:195], v5, s[20:23], s56 offen offset:0 sc1
    buffer_load_dwordx4 v[196:199], v5, s[20:23], s56 offen offset:1024 sc1
    buffer_load_dwordx4 v[200:203], v6, s[20:23], s56 offen offset:0 sc1
    buffer_load_dwordx4 v[204:207], v6, s[20:23], s56 offen offset:1024 sc1
    s_branch L_or0
L_og0:
    s_bitset0_b32 s52, 0
    v_mfma_f32_32x32x16_bf16 v[80:95], a[20:23], v[192:195], v[80:95]
    v_mfma_f32_32x32x16_bf16 v[80:95], a[28:31], v[196:199], v[80:95]
    v_mfma_f32_32x32x16_bf16 v[80:95], a[164:167], v[200:203], v[80:95]
    v_mfma_f32_32x32x16_bf16 v[80:95], a[172:175], v[204:207], v[80:95]
    v_mfma_f32_32x32x16_bf16 v[160:175], a[16:19], v[192:195], v[160:175]
    v_mfma_f32_32x32x16_bf16 v[160:175], a[24:27], v[196:199], v[160:175]
    v_mfma_f32_32x32x16_bf16 v[160:175], a[160:163], v[200:203], v[160:175]
    v_mfma_f32_32x32x16_bf16 v[160:175], a[168:171], v[204:207], v[160:175]
L_or0:
    s_bitcmp1_b32 s52, 1
    s_cbranch_scc0 L_or1
    v_max3_u32 v45, v240, v241, v242
    v_max3_u32 v46, v243, v244, v245
    v_max3_u32 v45, v246, v247, v45
    v_max3_u32 v46, v248, v249, v46
    v_max3_u32 v45, v250, v251, v45
    v_max3_u32 v46, v252, v253, v46
    v_max3_u32 v45, v254, v255, v45
    v_max_u32 v45, v45, v46
    v_cmp_eq_u32 vcc, -1, v45
    s_cbranch_vccz L_og1
    buffer_load_dwordx4 v[240:243], v5, s[20:23], s57 offen offset:0 sc1
    buffer_load_dwordx4 v[244:247], v5, s[20:23], s57 offen offset:1024 sc1
    buffer_load_dwordx4 v[248:251], v6, s[20:23], s57 offen offset:0 sc1
    buffer_load_dwordx4 v[252:255], v6, s[20:23], s57 offen offset:1024 sc1
    s_branch L_or1
L_og1:
    s_bitset0_b32 s52, 1
    v_mfma_f32_32x32x16_bf16 v[80:95], a[36:39], v[240:243], v[80:95]
    v_mfma_f32_32x32x16_bf16 v[80:95], a[44:47], v[244:247], v[80:95]
    v_mfma_f32_32x32x16_bf16 v[80:95], a[180:183], v[248:251], v[80:95]
    v_mfma_f32_32x32x16_bf16 v[80:95], a[188:191], v[252:255], v[80:95]
    v_mfma_f32_32x32x16_bf16 v[160:175], a[32:35], v[240:243], v[160:175]
    v_mfma_f32_32x32x16_bf16 v[160:175], a[40:43], v[244:247], v[160:175]
    v_mfma_f32_32x32x16_bf16 v[160:175], a[176:179], v[248:251], v[160:175]
    v_mfma_f32_32x32x16_bf16 v[160:175], a[184:187], v[252:255], v[160:175]
L_or1:
    s_bitcmp1_b32 s52, 2
    s_cbranch_scc0 L_or2
    v_max3_u32 v45, v208, v209, v210
    v_max3_u32 v46, v211, v212, v213
    v_max3_u32 v45, v214, v215, v45
    v_max3_u32 v46, v216, v217, v46
    v_max3_u32 v45, v218, v219, v45
    v_max3_u32 v46, v220, v221, v46
    v_max3_u32 v45, v222, v223, v45
    v_max_u32 v45, v45, v46
    v_cmp_eq_u32 vcc, -1, v45
    s_cbranch_vccz L_og2
    buffer_load_dwordx4 v[208:211], v5, s[20:23], s58 offen offset:0 sc1
    buffer_load_dwordx4 v[212:215], v5, s[20:23], s58 offen offset:1024 sc1
    buffer_load_dwordx4 v[216:219], v6, s[20:23], s58 offen offset:0 sc1
    buffer_load_dwordx4 v[220:223], v6, s[20:23], s58 offen offset:1024 sc1
    s_branch L_or2
L_og2:
    s_bitset0_b32 s52, 2
    v_mfma_f32_32x32x16_bf16 v[80:95], a[52:55], v[208:211], v[80:95]
    v_mfma_f32_32x32x16_bf16 v[80:95], a[60:63], v[212:215], v[80:95]
    v_mfma_f32_32x32x16_bf16 v[80:95], a[196:199], v[216:219], v[80:95]
    v_mfma_f32_32x32x16_bf16 v[80:95], a[204:207], v[220:223], v[80:95]
L_or2:
    s_bitcmp1_b32 s52, 3
    s_cbranch_scc0 L_or3
    v_max3_u32 v45, v224, v225, v226
    v_max3_u32 v46, v227, v228, v229
    v_max3_u32 v45, v230, v231, v45
    v_max3_u32 v46, v232, v233, v46
    v_max3_u32 v45, v234, v235, v45
    v_max3_u32 v46, v236, v237, v46
    v_max3_u32 v45, v238, v239, v45
    v_max_u32 v45, v45, v46
    v_cmp_eq_u32 vcc, -1, v45
    s_cbranch_vccz L_og3
    buffer_load_dwordx4 v[224:227], v5, s[20:23], s59 offen offset:0 sc1
    buffer_load_dwordx4 v[228:231], v5, s[20:23], s59 offen offset:1024 sc1
    buffer_load_dwordx4 v[232:235], v6, s[20:23], s59 offen offset:0 sc1
    buffer_load_dwordx4 v[236:239], v6, s[20:23], s59 offen offset:1024 sc1
    s_branch L_or3
L_og3:
    s_bitset0_b32 s52, 3
    v_mfma_f32_32x32x16_bf16 v[80:95], a[68:71], v[224:227], v[80:95]
    v_mfma_f32_32x32x16_bf16 v[80:95], a[76:79], v[228:231], v[80:95]
    v_mfma_f32_32x32x16_bf16 v[80:95], a[228:231], v[232:235], v[80:95]
    v_mfma_f32_32x32x16_bf16 v[80:95], a[236:239], v[236:239], v[80:95]
L_or3:
    s_cmp_lg_u32 s52, 0
    s_cbranch_scc0 L_odone
    s_sub_u32 s72, s72, 1
    s_cbranch_scc0 L_or
    s_waitcnt vmcnt(0) lgkmcnt(0)
    s_branch L_odone
L_fallback:
    s_waitcnt vmcnt(0) lgkmcnt(0)
    s_mul_i32 s52, s5, 458752
    s_sub_u32 s66, s74, s52
    s_lshl_b32 s52, s5, 15
    s_sub_u32 s67, s75, s52
    s_mov_b32 s54, 64
    v_mov_b32 v41, 0xff800000
L_fb1:
    buffer_load_dwordx4 a[0:3], v2, s[20:23], s66 offen offset:0 sc1
    buffer_load_dwordx4 a[4:7], v2, s[20:23], s66 offen offset:1024 sc1
    s_add_u32 s66, s66, 28672
    s_waitcnt vmcnt(0) lgkmcnt(0)
    v_mfma_f32_32x32x16_bf16 v[192:207], a[0:3], a[224:227], 0
    v_mfma_f32_32x32x16_bf16 v[192:207], a[4:7], a[228:231], v[192:207]
    s_nop 15
    v_max3_f32 v41, v192, v193, v41
    v_max3_f32 v41, v194, v195, v41
    v_max3_f32 v41, v196, v197, v41
    v_max3_f32 v41, v198, v199, v41
    v_max3_f32 v41, v200, v201, v41
    v_max3_f32 v41, v202, v203, v41
    v_max3_f32 v41, v204, v205, v41
    v_max3_f32 v41, v206, v207, v41
    s_sub_u32 s54, s54, 1
    s_cmp_lg_u32 s54, 0
    s_cbranch_scc1 L_fb1
    v_mov_b32 v42, v41
    s_nop 1
    v_permlane32_swap_b32 v41, v42
    s_nop 1
    v_max_f32 v41, v41, v42
    v_sub_f32 v208, 0, v41
    v_mov_b32 v144, 0
    v_sub_f32 v209, 0, v41
    v_mov_b32 v145, 0
    v_sub_f32 v210, 0, v41
    v_mov_b32 v146, 0
    v_sub_f32 v211, 0, v41
    v_mov_b32 v147, 0
    v_sub_f32 v212, 0, v41
    v_mov_b32 v148, 0
    v_sub_f32 v213, 0, v41
    v_mov_b32 v149, 0
    v_sub_f32 v214, 0, v41
    v_mov_b32 v150, 0
    v_sub_f32 v215, 0, v41
    v_mov_b32 v151, 0
    v_sub_f32 v216, 0, v41
    v_mov_b32 v152, 0
    v_sub_f32 v217, 0, v41
    v_mov_b32 v153, 0
    v_sub_f32 v218, 0, v41
    v_mov_b32 v154, 0
    v_sub_f32 v219, 0, v41
    v_mov_b32 v155, 0
    v_sub_f32 v220, 0, v41
    v_mov_b32 v156, 0
    v_sub_f32 v221, 0, v41
    v_mov_b32 v157, 0
    v_sub_f32 v222, 0, v41
    v_mov_b32 v158, 0
    v_sub_f32 v223, 0, v41
    v_mov_b32 v159, 0
    s_mul_i32 s52, s5, 458752
    s_sub_u32 s66, s74, s52
    s_lshl_b32 s52, s5, 15
    s_sub_u32 s67, s75, s52
    s_mov_b32 s54, 64
L_fb2:
    buffer_load_dwordx4 a[0:3], v2, s[20:23], s66 offen offset:0 sc1
    buffer_load_dwordx4 a[4:7], v2, s[20:23], s66 offen offset:1024 sc1
    buffer_load_dwordx4 a[8:11], v36, s[20:23], s67 offen offset:0 sc1
    buffer_load_dwordx4 a[12:15], v36, s[20:23], s67 offen offset:1024 sc1
    s_add_u32 s66, s66, 28672
    s_add_u32 s67, s67, 2048
    s_waitcnt vmcnt(0) lgkmcnt(0)
    v_mfma_f32_32x32x16_bf16 v[192:207], a[0:3], a[224:227], v[208:223]
    v_mfma_f32_32x32x16_bf16 v[192:207], a[4:7], a[228:231], v[192:207]
    s_nop 15
    v_exp_f32 v192, v192
    v_exp_f32 v193, v193
    v_exp_f32 v194, v194
    v_exp_f32 v195, v195
    v_exp_f32 v196, v196
    v_exp_f32 v197, v197
    v_exp_f32 v198, v198
    v_exp_f32 v199, v199
    v_exp_f32 v200, v200
    v_exp_f32 v201, v201
    v_exp_f32 v202, v202
    v_exp_f32 v203, v203
    v_exp_f32 v204, v204
    v_exp_f32 v205, v205
    v_exp_f32 v206, v206
    v_exp_f32 v207, v207
    v_cvt_pk_bf16_f32 v240, v192, v193
    v_cvt_pk_bf16_f32 v241, v194, v195
    v_cvt_pk_bf16_f32 v242, v196, v197
    v_cvt_pk_bf16_f32 v243, v198, v199
    v_cvt_pk_bf16_f32 v244, v200, v201
    v_cvt_pk_bf16_f32 v245, v202, v203
    v_cvt_pk_bf16_f32 v246, v204, v205
    v_cvt_pk_bf16_f32 v247, v206, v207
    s_nop 1
    v_mfma_f32_32x32x16_bf16 v[144:159], a[8:11], v[240:243], v[144:159]
    v_mfma_f32_32x32x16_bf16 v[144:159], a[12:15], v[244:247], v[144:159]
    s_nop 15
    s_sub_u32 s54, s54, 1
    s_cmp_lg_u32 s54, 0
    s_cbranch_scc1 L_fb2
    v_mov_b32 v41, v156
    v_mov_b32 v42, v156
    s_nop 1
    v_permlane32_swap_b32 v41, v42
    s_nop 1
    s_branch L_norm
L_code_end:
.section .rodata,"a"
.p2align 6
.amdhsa_kernel gated_mix__softmax_full_mha__dense_activation_mish__prompt_kernel
  .amdhsa_next_free_vgpr 512
  .amdhsa_next_free_sgpr 102
  .amdhsa_accum_offset 256
  .amdhsa_group_segment_fixed_size 0
  .amdhsa_kernarg_size 88
  .amdhsa_user_sgpr_count 2
  .amdhsa_user_sgpr_kernarg_segment_ptr 1
  .amdhsa_system_sgpr_workgroup_id_x 1
.end_amdhsa_kernel
```
